```python
import torch

def _softmax(x, axis=-1):
    return torch.softmax(x, dim=axis)
def _gelu(x):
    return torch.nn.functional.gelu(x, approximate="tanh")
def _silu(x):
    return torch.nn.functional.silu(x)
def _sigmoid(x):
    return torch.sigmoid(x)
def _layernorm(x, axis=-1, eps=1e-5):
    m = x.mean(dim=axis, keepdim=True)
    v = x.var(dim=axis, keepdim=True, unbiased=False)
    return (x - m) / torch.sqrt(v + eps)
def _scatter_add(tgt, idx, src, axis=0):
    return tgt.clone().index_add_(axis, idx, src)
def _segment_sum(src, seg, n):
    out = torch.zeros((n,) + src.shape[1:], dtype=src.dtype)
    return out.index_add_(0, seg, src)
def _pad(x, pw):
    flat = tuple(v for pair in reversed(pw) for v in pair)
    return torch.nn.functional.pad(x, flat)

kernel_name = 'standalone__mha_block_cached__near_ridge'

def setup_inputs():

    _w = (lambda a: (lambda t: t.to(torch.bfloat16) if t.is_floating_point() else t)(torch.as_tensor(a)))
    B, Sq, D = 16, 48, 640
    H, Sk, Dh = 32, 48, 192
    return {
        "x": _w((lambda *s: torch.randn(*s, dtype=torch.bfloat16) * 0.8)(B, Sq, D)),
        "k_cache": _w((lambda *s: torch.randn(*s, dtype=torch.bfloat16) * 0.8)(B, H, Sk, Dh)),
        "v_cache": _w((lambda *s: torch.randn(*s, dtype=torch.bfloat16) * 0.05)(B, H, Sk, Dh)),
        "wq": _w((lambda *s: torch.randn(*s, dtype=torch.bfloat16) * 0.8)(D, H * Dh) * (D ** -0.5)),
        "wo": _w((lambda *s: torch.randn(*s, dtype=torch.bfloat16) * 0.05)(H * Dh, D) * ((H * Dh) ** -0.5)),
    }

def reference(x, k_cache, v_cache, wq, wo):
    B, Sq, D = x.shape
    H, Dh = 32, 192
    q = (lambda x, *d: x.permute(*d))((x @ wq).reshape(B, Sq, H, Dh), 0, 2, 1, 3)
    scores = torch.einsum("bhqd,bhkd->bhqk", q, k_cache) * (Dh ** -0.5)
    p = _softmax(scores, axis=-1)
    o = torch.einsum("bhqk,bhkd->bhqd", p, v_cache)
    return (lambda x, *d: x.permute(*d))(o, 0, 2, 1, 3).reshape(B, Sq, H * Dh) @ wo
```

```asm
; @launch grid=(256,1,1) block=(512,1,1) lds=163840
.amdgcn_target "amdgcn-amd-amdhsa--gfx950"
.text
.globl standalone__mha_block_cached__near_ridge_kernel
.p2align 8
.type standalone__mha_block_cached__near_ridge_kernel,@function
standalone__mha_block_cached__near_ridge_kernel:
    s_cmp_ge_u32 s2, 256
    s_cbranch_scc1 KA_END
    s_load_dwordx4 s[8:11], s[0:1], 16
    s_load_dwordx4 s[4:7], s[0:1], 0
    s_load_dwordx2 s[14:15], s[0:1], 32
    s_load_dwordx4 s[16:19], s[0:1], 48
    v_lshrrev_b32 v1, 6, v0
    v_and_b32 v0, 63, v0
    v_readfirstlane_b32 s23, v1
    s_and_b32 s3, s2, 7
    s_lshr_b32 s21, s2, 3
    s_and_b32 s22, s21, 3
    s_lshl_b32 s20, s3, 2
    s_add_u32 s20, s20, s22
    s_lshr_b32 s21, s21, 2
    s_cmp_ge_u32 s23, 4
    s_cbranch_scc1 KA_LOADER
    s_cmp_ge_u32 s2, 32
    s_cbranch_scc1 KA_NIPF
    s_and_b32 s24, s23, 3
    s_getpc_b64 s[36:37]
KA_PC:
    s_sub_u32 s36, s36, KA_PC - standalone__mha_block_cached__near_ridge_kernel
    s_subb_u32 s37, s37, 0
    s_lshl_b32 s24, s24, 13
    v_lshlrev_b32 v2, 7, v0
    v_add_u32 v2, s24, v2
    v_min_u32 v2, KA_END - standalone__mha_block_cached__near_ridge_kernel, v2
    v_mov_b32 v3, s37
    v_add_co_u32 v2, vcc, s36, v2
    s_nop 1
    v_addc_co_u32 v3, vcc, 0, v3, vcc
    global_load_dword v30, v[2:3], off
KA_NIPF:
    s_branch KA_COMPUTE
KA_LOADER:
    s_and_b32 s24, s23, 3
    s_mul_i32 s25, s24, 196608
    s_mul_i32 s26, s20, 384
    s_add_u32 s25, s25, s26
    v_add_u32 v40, 0, v0
    v_mul_u32_u24 v2, 2731, v40
    v_lshrrev_b32 v44, 16, v2
    v_mul_u32_u24 v3, 24, v44
    v_sub_u32 v3, v40, v3
    v_and_b32 v4, 2, v44
    v_xor_b32 v3, v3, v4
    v_mul_u32_u24 v2, 12288, v44
    v_lshl_add_u32 v2, v3, 4, v2
    v_add_u32 v8, s25, v2
    v_add_u32 v41, 64, v0
    v_mul_u32_u24 v2, 2731, v41
    v_lshrrev_b32 v45, 16, v2
    v_mul_u32_u24 v3, 24, v45
    v_sub_u32 v3, v41, v3
    v_and_b32 v4, 2, v45
    v_xor_b32 v3, v3, v4
    v_mul_u32_u24 v2, 12288, v45
    v_lshl_add_u32 v2, v3, 4, v2
    v_add_u32 v9, s25, v2
    v_add_u32 v42, 128, v0
    v_mul_u32_u24 v2, 2731, v42
    v_lshrrev_b32 v46, 16, v2
    v_mul_u32_u24 v3, 24, v46
    v_sub_u32 v3, v42, v3
    v_and_b32 v4, 2, v46
    v_xor_b32 v3, v3, v4
    v_mul_u32_u24 v2, 12288, v46
    v_lshl_add_u32 v2, v3, 4, v2
    v_add_u32 v10, s25, v2
    v_xor_b32 v11, 64, v8
    v_add_u32 v11, 95232, v11
    v_xor_b32 v12, 64, v9
    v_add_u32 v12, 98304, v12
    v_xor_b32 v13, 64, v10
    v_add_u32 v13, 97280, v13
    v_subrev_u32 v9, 1024, v9
    v_subrev_u32 v10, 2048, v10
    s_add_u32 s40, s22, s21
    s_and_b32 s40, s40, 3
    s_mul_i32 s40, s40, 5
    s_lshr_b32 s40, s40, 1
    s_add_u32 s40, s40, s3
    s_sub_u32 s41, s40, 10
    s_cmp_ge_u32 s40, 10
    s_cselect_b32 s40, s41, s40
    s_lshl_b32 s41, s40, 7
    s_mul_i32 s40, s40, 786432
    s_mul_i32 s43, s24, 6144
    s_mul_i32 s44, s24, 3072
    s_mov_b32 s30, 7864320
    s_mov_b32 s31, 0x00020000
    s_waitcnt lgkmcnt(0)
    s_mov_b32 s28, s10
    s_mov_b32 s29, s11
    s_add_u32 m0, s43, 73728
    s_nop 0
    buffer_load_dwordx4 v8, s[28:31], s40 offen offset:0 lds
    buffer_load_dwordx4 v9, s[28:31], s40 offen offset:1024 lds
    buffer_load_dwordx4 v10, s[28:31], s40 offen offset:2048 lds
    buffer_load_dwordx4 v11, s[28:31], s40 offen offset:3072 lds
    s_add_u32 m0, m0, 4096
    s_nop 0
    buffer_load_dwordx4 v12, s[28:31], s40 offen offset:0 lds
    buffer_load_dwordx4 v13, s[28:31], s40 offen offset:1024 lds
    s_add_u32 s40, s40, 786432
    s_cmp_eq_u32 s40, 7864320
    s_cselect_b32 s40, 0, s40
    s_mul_i32 s25, s21, 96
    s_mul_i32 s26, s24, 24
    s_add_u32 s25, s25, s26
    s_mul_i32 s25, s25, 1280
    s_and_b32 s26, s24, 1
    s_lshl_b32 s26, s26, 6
    v_lshrrev_b32 v47, 3, v0
    v_and_b32 v2, 7, v0
    v_lshrrev_b32 v3, 4, v0
    v_xor_b32 v2, v2, v3
    v_lshlrev_b32 v48, 4, v2
    v_xor_b32 v48, s26, v48
    v_mul_u32_u24 v1, 1280, v47
    v_add3_u32 v14, s25, v1, v48
    v_xor_b32 v15, 64, v14
    v_add_u32 v15, 9216, v15
    v_add_u32 v16, 18432, v14
    s_mov_b32 s32, s4
    s_mov_b32 s33, s5
    s_mov_b32 s34, 983040
    s_mov_b32 s35, 0x00020000
    s_add_u32 m0, s44, 98304
    s_nop 0
    buffer_load_dwordx4 v14, s[32:35], s41 offen offset:0 lds
    buffer_load_dwordx4 v15, s[32:35], s41 offen offset:1024 lds
    buffer_load_dwordx4 v16, s[32:35], s41 offen offset:2048 lds
    s_add_u32 s41, s41, 128
    s_cmp_eq_u32 s41, 1280
    s_cselect_b32 s41, 0, s41
    s_add_u32 m0, s43, 0
    s_nop 0
    buffer_load_dwordx4 v8, s[28:31], s40 offen offset:0 lds
    buffer_load_dwordx4 v9, s[28:31], s40 offen offset:1024 lds
    buffer_load_dwordx4 v10, s[28:31], s40 offen offset:2048 lds
    buffer_load_dwordx4 v11, s[28:31], s40 offen offset:3072 lds
    s_add_u32 m0, m0, 4096
    s_nop 0
    buffer_load_dwordx4 v12, s[28:31], s40 offen offset:0 lds
    buffer_load_dwordx4 v13, s[28:31], s40 offen offset:1024 lds
    s_add_u32 s40, s40, 786432
    s_cmp_eq_u32 s40, 7864320
    s_cselect_b32 s40, 0, s40
    s_add_u32 m0, s44, 24576
    s_nop 0
    buffer_load_dwordx4 v14, s[32:35], s41 offen offset:0 lds
    buffer_load_dwordx4 v15, s[32:35], s41 offen offset:1024 lds
    buffer_load_dwordx4 v16, s[32:35], s41 offen offset:2048 lds
    s_add_u32 s41, s41, 128
    s_cmp_eq_u32 s41, 1280
    s_cselect_b32 s41, 0, s41
    s_mov_b32 s12, s18
    s_mov_b32 s13, s19
    s_add_u32 s36, s18, 4194304
    s_addc_u32 s37, s19, 0
    s_mov_b32 s38, 589824
    s_mov_b32 s39, 0x00020000
    v_lshlrev_b32 v50, 2, v0
    v_mov_b32 v51, 0
    s_lshl_b32 s46, s2, 8
    buffer_store_dword v51, v50, s[36:39], s46 offen sc1
    s_mul_i32 s53, s21, 11
    s_lshr_b32 s53, s53, 5
    s_mul_i32 s52, s53, 3
    s_sub_u32 s52, s21, s52
    s_mov_b32 s48, s22
    s_mov_b32 s53, 0
    s_add_u32 s26, s53, 0
    s_sub_u32 s27, s26, 3
    s_cmp_ge_u32 s26, 3
    s_cselect_b32 s26, s27, s26
    s_add_u32 s26, s26, s22
    s_add_u32 s26, s26, 1
    s_and_b32 s49, s26, 3
    s_add_u32 s26, s53, 1
    s_sub_u32 s27, s26, 3
    s_cmp_ge_u32 s26, 3
    s_cselect_b32 s26, s27, s26
    s_add_u32 s26, s26, s22
    s_add_u32 s26, s26, 1
    s_and_b32 s50, s26, 3
    s_add_u32 s26, s53, 2
    s_sub_u32 s27, s26, 3
    s_cmp_ge_u32 s26, 3
    s_cselect_b32 s26, s27, s26
    s_add_u32 s26, s26, s22
    s_add_u32 s26, s26, 1
    s_and_b32 s51, s26, 3
    s_and_b32 s26, s24, 1
    s_lshr_b32 s27, s24, 1
    s_lshl_b32 s25, s21, 1
    s_add_u32 s25, s25, s26
    s_lshl_b32 s25, s25, 5
    s_add_u32 s25, s25, s20
    s_mul_i32 s25, s25, 18432
    s_mul_i32 s47, s27, 9216
    s_add_u32 s25, s25, s47
    s_mul_i32 s26, s26, 18432
    s_add_u32 s47, s47, s26
    s_lshl_b32 s27, s27, 6
    v_bfe_u32 v3, v44, 2, 1
    v_and_b32 v4, 2, v44
    v_or_b32 v3, v3, v4
    v_xor_b32 v3, v3, v0
    v_lshlrev_b32 v3, 4, v3
    v_xor_b32 v20, s27, v3
    v_xor_b32 v23, 64, v20
    v_bfe_u32 v3, v45, 2, 1
    v_and_b32 v4, 2, v45
    v_or_b32 v3, v3, v4
    v_xor_b32 v3, v3, v0
    v_lshlrev_b32 v3, 4, v3
    v_xor_b32 v21, s27, v3
    v_xor_b32 v24, 64, v21
    v_bfe_u32 v3, v46, 2, 1
    v_and_b32 v4, 2, v46
    v_or_b32 v3, v3, v4
    v_xor_b32 v3, v3, v0
    v_lshlrev_b32 v3, 4, v3
    v_xor_b32 v22, s27, v3
    v_xor_b32 v25, 64, v22
    s_mul_i32 s26, s3, 768
    s_lshl_b32 s27, s24, 4
    s_add_u32 s26, s26, s27
    s_mul_i32 s26, s26, 1280
    s_mul_i32 s27, s22, 320
    s_add_u32 s26, s26, s27
    v_add_u32 v1, 0, v0
    v_mul_u32_u24 v2, 3277, v1
    v_lshrrev_b32 v2, 16, v2
    v_mul_u32_u24 v3, 20, v2
    v_sub_u32 v3, v1, v3
    v_bfe_u32 v4, v2, 3, 1
    v_lshlrev_b32 v4, 1, v4
    v_xor_b32 v3, v3, v4
    v_mul_u32_u24 v2, 1280, v2
    v_lshl_add_u32 v2, v3, 4, v2
    v_add_u32 v30, s26, v2
    v_add_u32 v1, 64, v0
    v_mul_u32_u24 v2, 3277, v1
    v_lshrrev_b32 v2, 16, v2
    v_mul_u32_u24 v3, 20, v2
    v_sub_u32 v3, v1, v3
    v_bfe_u32 v4, v2, 3, 1
    v_lshlrev_b32 v4, 1, v4
    v_xor_b32 v3, v3, v4
    v_mul_u32_u24 v2, 1280, v2
    v_lshl_add_u32 v2, v3, 4, v2
    v_add_u32 v31, s26, v2
    v_subrev_u32 v31, 1024, v31
    v_add_u32 v1, 128, v0
    v_mul_u32_u24 v2, 3277, v1
    v_lshrrev_b32 v2, 16, v2
    v_mul_u32_u24 v3, 20, v2
    v_sub_u32 v3, v1, v3
    v_bfe_u32 v4, v2, 3, 1
    v_lshlrev_b32 v4, 1, v4
    v_xor_b32 v3, v3, v4
    v_mul_u32_u24 v2, 1280, v2
    v_lshl_add_u32 v2, v3, 4, v2
    v_add_u32 v32, s26, v2
    v_subrev_u32 v32, 2048, v32
    v_add_u32 v1, 192, v0
    v_mul_u32_u24 v2, 3277, v1
    v_lshrrev_b32 v2, 16, v2
    v_mul_u32_u24 v3, 20, v2
    v_sub_u32 v3, v1, v3
    v_bfe_u32 v4, v2, 3, 1
    v_lshlrev_b32 v4, 1, v4
    v_xor_b32 v3, v3, v4
    v_mul_u32_u24 v2, 1280, v2
    v_lshl_add_u32 v2, v3, 4, v2
    v_add_u32 v33, s26, v2
    v_subrev_u32 v33, 3072, v33
    v_add_u32 v1, 256, v0
    v_mul_u32_u24 v2, 3277, v1
    v_lshrrev_b32 v2, 16, v2
    v_mul_u32_u24 v3, 20, v2
    v_sub_u32 v3, v1, v3
    v_bfe_u32 v4, v2, 3, 1
    v_lshlrev_b32 v4, 1, v4
    v_xor_b32 v3, v3, v4
    v_mul_u32_u24 v2, 1280, v2
    v_lshl_add_u32 v2, v3, 4, v2
    v_add_u32 v34, s26, v2
    s_lshr_b32 s26, s24, 1
    s_lshl_b32 s27, s21, 1
    s_add_u32 s26, s26, s27
    s_lshl_b32 s26, s26, 5
    s_lshl_b32 s27, s3, 2
    s_add_u32 s26, s26, s27
    s_mul_i32 s26, s26, 18432
    s_and_b32 s27, s24, 1
    s_mul_i32 s27, s27, 9216
    s_add_u32 s26, s26, s27
    v_mul_u32_u24 v1, 384, v47
    v_add3_u32 v26, s26, v1, v48
    v_xor_b32 v27, 64, v26
    v_add_u32 v27, 2048, v27
    v_add_u32 v28, 4096, v26
    s_mul_i32 s45, s24, 5120
    s_lshl_b32 s26, s21, 3
    s_add_u32 s26, s26, s3
    s_lshl_b32 s26, s26, 2
    s_lshl_b32 s27, 1, s22
    v_mov_b32 v52, 2147483392
    v_mov_b32 v53, s27
    v_writelane_b32 v52, s26, 0
    v_lshlrev_b32 v55, 4, v0
    v_and_b32 v62, 15, v0
    v_lshlrev_b32 v62, 2, v62
    s_mov_b32 s56, s6
    s_mov_b32 s57, s7
    s_mov_b32 s58, 9437184
    s_mov_b32 s59, 0x00020000
    s_mov_b32 s60, s8
    s_mov_b32 s61, s9
    s_mov_b32 s62, 9437184
    s_mov_b32 s63, 0x00020000
    s_mov_b32 s64, s14
    s_mov_b32 s65, s15
    s_mov_b32 s66, 7864320
    s_mov_b32 s67, 0x00020000
    v_add_u32 v37, s44, v55
    v_add_u32 v38, s45, v55
    v_add_u32 v39, 73728, v37
    v_add_u32 v36, 73728, v38
    s_mul_i32 s42, s22, 3
    s_add_u32 s42, s42, s21
    s_sub_u32 s26, s42, 6
    s_cmp_ge_u32 s42, 6
    s_cselect_b32 s42, s26, s42
    s_sub_u32 s26, s42, 6
    s_cmp_ge_u32 s42, 6
    s_cselect_b32 s42, s26, s42
    s_sub_u32 s26, s42, 6
    s_cmp_ge_u32 s42, 6
    s_cselect_b32 s42, s26, s42
    s_add_u32 s42, s42, 1
    s_waitcnt vmcnt(10)
    s_barrier
    s_add_u32 m0, s43, 36864
    s_nop 0
    buffer_load_dwordx4 v8, s[28:31], s40 offen offset:0 lds
    buffer_load_dwordx4 v9, s[28:31], s40 offen offset:1024 lds
    buffer_load_dwordx4 v10, s[28:31], s40 offen offset:2048 lds
    buffer_load_dwordx4 v11, s[28:31], s40 offen offset:3072 lds
    s_add_u32 m0, m0, 4096
    s_nop 0
    buffer_load_dwordx4 v12, s[28:31], s40 offen offset:0 lds
    buffer_load_dwordx4 v13, s[28:31], s40 offen offset:1024 lds
    s_add_u32 s40, s40, 786432
    s_cmp_eq_u32 s40, 7864320
    s_cselect_b32 s40, 0, s40
    s_add_u32 m0, s44, 61440
    s_nop 0
    buffer_load_dwordx4 v14, s[32:35], s41 offen offset:0 lds
    buffer_load_dwordx4 v15, s[32:35], s41 offen offset:1024 lds
    buffer_load_dwordx4 v16, s[32:35], s41 offen offset:2048 lds
    s_add_u32 s41, s41, 128
    s_cmp_eq_u32 s41, 1280
    s_cselect_b32 s41, 0, s41
    s_waitcnt vmcnt(9)
    s_barrier
    s_mov_b32 s36, s16
    s_mov_b32 s37, s17
    s_mov_b32 s38, 256
    s_mov_b32 s39, 0x00020000
    s_cmp_lg_u32 s24, 0
    s_cselect_b32 s38, 0, s38
    buffer_atomic_or v53, v52, s[36:39], 0 offen
    s_mov_b32 s38, 256
    s_add_u32 m0, s43, 73728
    s_nop 0
    buffer_load_dwordx4 v8, s[28:31], s40 offen offset:0 lds
    buffer_load_dwordx4 v9, s[28:31], s40 offen offset:1024 lds
    buffer_load_dwordx4 v10, s[28:31], s40 offen offset:2048 lds
    buffer_load_dwordx4 v11, s[28:31], s40 offen offset:3072 lds
    s_add_u32 m0, m0, 4096
    s_nop 0
    buffer_load_dwordx4 v12, s[28:31], s40 offen offset:0 lds
    buffer_load_dwordx4 v13, s[28:31], s40 offen offset:1024 lds
    s_add_u32 s40, s40, 786432
    s_cmp_eq_u32 s40, 7864320
    s_cselect_b32 s40, 0, s40
    s_add_u32 m0, s44, 98304
    s_nop 0
    buffer_load_dwordx4 v14, s[32:35], s41 offen offset:0 lds
    buffer_load_dwordx4 v15, s[32:35], s41 offen offset:1024 lds
    buffer_load_dwordx4 v16, s[32:35], s41 offen offset:2048 lds
    s_add_u32 s41, s41, 128
    s_cmp_eq_u32 s41, 1280
    s_cselect_b32 s41, 0, s41
    s_waitcnt vmcnt(10)
    s_barrier
    s_add_u32 m0, s43, 0
    s_nop 0
    buffer_load_dwordx4 v8, s[28:31], s40 offen offset:0 lds
    buffer_load_dwordx4 v9, s[28:31], s40 offen offset:1024 lds
    buffer_load_dwordx4 v10, s[28:31], s40 offen offset:2048 lds
    buffer_load_dwordx4 v11, s[28:31], s40 offen offset:3072 lds
    s_add_u32 m0, m0, 4096
    s_nop 0
    buffer_load_dwordx4 v12, s[28:31], s40 offen offset:0 lds
    buffer_load_dwordx4 v13, s[28:31], s40 offen offset:1024 lds
    s_add_u32 s40, s40, 786432
    s_cmp_eq_u32 s40, 7864320
    s_cselect_b32 s40, 0, s40
    s_add_u32 m0, s44, 24576
    s_nop 0
    buffer_load_dwordx4 v14, s[32:35], s41 offen offset:0 lds
    buffer_load_dwordx4 v15, s[32:35], s41 offen offset:1024 lds
    buffer_load_dwordx4 v16, s[32:35], s41 offen offset:2048 lds
    s_add_u32 s41, s41, 128
    s_cmp_eq_u32 s41, 1280
    s_cselect_b32 s41, 0, s41
    s_cmp_lg_u32 s42, 1
    s_cbranch_scc1 KA_NK1
    s_add_u32 m0, s47, 110592
    s_nop 0
    buffer_load_dwordx4 v20, s[56:59], s25 offen offset:0 nt lds
    buffer_load_dwordx4 v21, s[56:59], s25 offen offset:1024 nt lds
    buffer_load_dwordx4 v22, s[56:59], s25 offen offset:2048 nt lds
    s_add_u32 s25, s25, 3072
    s_add_u32 m0, s47, 113664
    s_nop 0
    buffer_load_dwordx4 v23, s[56:59], s25 offen offset:0 nt lds
    buffer_load_dwordx4 v24, s[56:59], s25 offen offset:1024 nt lds
    buffer_load_dwordx4 v25, s[56:59], s25 offen offset:2048 nt lds
    s_add_u32 s25, s25, 3072
    s_add_u32 m0, s47, 116736
    s_nop 0
    buffer_load_dwordx4 v20, s[56:59], s25 offen offset:0 nt lds
    buffer_load_dwordx4 v21, s[56:59], s25 offen offset:1024 nt lds
    buffer_load_dwordx4 v22, s[56:59], s25 offen offset:2048 nt lds
KA_NK1:
    s_sub_u32 s26, 1, s42
    s_cmp_le_u32 s26, 1
    s_cbranch_scc1 KA_KX2
    s_waitcnt vmcnt(9)
KA_KX2:
    s_waitcnt vmcnt(18)
    s_barrier
    s_add_u32 m0, s43, 36864
    s_nop 0
    buffer_load_dwordx4 v8, s[28:31], s40 offen offset:0 lds
    buffer_load_dwordx4 v9, s[28:31], s40 offen offset:1024 lds
    buffer_load_dwordx4 v10, s[28:31], s40 offen offset:2048 lds
    buffer_load_dwordx4 v11, s[28:31], s40 offen offset:3072 lds
    s_add_u32 m0, m0, 4096
    s_nop 0
    buffer_load_dwordx4 v12, s[28:31], s40 offen offset:0 lds
    buffer_load_dwordx4 v13, s[28:31], s40 offen offset:1024 lds
    s_add_u32 s40, s40, 786432
    s_cmp_eq_u32 s40, 7864320
    s_cselect_b32 s40, 0, s40
    s_add_u32 m0, s44, 61440
    s_nop 0
    buffer_load_dwordx4 v14, s[32:35], s41 offen offset:0 lds
    buffer_load_dwordx4 v15, s[32:35], s41 offen offset:1024 lds
    buffer_load_dwordx4 v16, s[32:35], s41 offen offset:2048 lds
    s_add_u32 s41, s41, 128
    s_cmp_eq_u32 s41, 1280
    s_cselect_b32 s41, 0, s41
    s_cmp_lg_u32 s42, 2
    s_cbranch_scc1 KA_NK2
    s_add_u32 m0, s47, 110592
    s_nop 0
    buffer_load_dwordx4 v20, s[56:59], s25 offen offset:0 nt lds
    buffer_load_dwordx4 v21, s[56:59], s25 offen offset:1024 nt lds
    buffer_load_dwordx4 v22, s[56:59], s25 offen offset:2048 nt lds
    s_add_u32 s25, s25, 3072
    s_add_u32 m0, s47, 113664
    s_nop 0
    buffer_load_dwordx4 v23, s[56:59], s25 offen offset:0 nt lds
    buffer_load_dwordx4 v24, s[56:59], s25 offen offset:1024 nt lds
    buffer_load_dwordx4 v25, s[56:59], s25 offen offset:2048 nt lds
    s_add_u32 s25, s25, 3072
    s_add_u32 m0, s47, 116736
    s_nop 0
    buffer_load_dwordx4 v20, s[56:59], s25 offen offset:0 nt lds
    buffer_load_dwordx4 v21, s[56:59], s25 offen offset:1024 nt lds
    buffer_load_dwordx4 v22, s[56:59], s25 offen offset:2048 nt lds
KA_NK2:
    s_sub_u32 s26, 2, s42
    s_cmp_le_u32 s26, 1
    s_cbranch_scc1 KA_KX3
    s_waitcnt vmcnt(9)
KA_KX3:
    s_waitcnt vmcnt(18)
    s_barrier
    s_add_u32 m0, s43, 73728
    s_nop 0
    buffer_load_dwordx4 v8, s[28:31], s40 offen offset:0 lds
    buffer_load_dwordx4 v9, s[28:31], s40 offen offset:1024 lds
    buffer_load_dwordx4 v10, s[28:31], s40 offen offset:2048 lds
    buffer_load_dwordx4 v11, s[28:31], s40 offen offset:3072 lds
    s_add_u32 m0, m0, 4096
    s_nop 0
    buffer_load_dwordx4 v12, s[28:31], s40 offen offset:0 lds
    buffer_load_dwordx4 v13, s[28:31], s40 offen offset:1024 lds
    s_add_u32 s40, s40, 786432
    s_cmp_eq_u32 s40, 7864320
    s_cselect_b32 s40, 0, s40
    s_add_u32 m0, s44, 98304
    s_nop 0
    buffer_load_dwordx4 v14, s[32:35], s41 offen offset:0 lds
    buffer_load_dwordx4 v15, s[32:35], s41 offen offset:1024 lds
    buffer_load_dwordx4 v16, s[32:35], s41 offen offset:2048 lds
    s_add_u32 s41, s41, 128
    s_cmp_eq_u32 s41, 1280
    s_cselect_b32 s41, 0, s41
    s_cmp_lg_u32 s42, 3
    s_cbranch_scc1 KA_NK3
    s_add_u32 m0, s47, 110592
    s_nop 0
    buffer_load_dwordx4 v20, s[56:59], s25 offen offset:0 nt lds
    buffer_load_dwordx4 v21, s[56:59], s25 offen offset:1024 nt lds
    buffer_load_dwordx4 v22, s[56:59], s25 offen offset:2048 nt lds
    s_add_u32 s25, s25, 3072
    s_add_u32 m0, s47, 113664
    s_nop 0
    buffer_load_dwordx4 v23, s[56:59], s25 offen offset:0 nt lds
    buffer_load_dwordx4 v24, s[56:59], s25 offen offset:1024 nt lds
    buffer_load_dwordx4 v25, s[56:59], s25 offen offset:2048 nt lds
    s_add_u32 s25, s25, 3072
    s_add_u32 m0, s47, 116736
    s_nop 0
    buffer_load_dwordx4 v20, s[56:59], s25 offen offset:0 nt lds
    buffer_load_dwordx4 v21, s[56:59], s25 offen offset:1024 nt lds
    buffer_load_dwordx4 v22, s[56:59], s25 offen offset:2048 nt lds
KA_NK3:
    s_sub_u32 s26, 3, s42
    s_cmp_le_u32 s26, 1
    s_cbranch_scc1 KA_KX4
    s_waitcnt vmcnt(9)
KA_KX4:
    s_waitcnt vmcnt(18)
    s_barrier
    s_add_u32 m0, s43, 0
    s_nop 0
    buffer_load_dwordx4 v8, s[28:31], s40 offen offset:0 lds
    buffer_load_dwordx4 v9, s[28:31], s40 offen offset:1024 lds
    buffer_load_dwordx4 v10, s[28:31], s40 offen offset:2048 lds
    buffer_load_dwordx4 v11, s[28:31], s40 offen offset:3072 lds
    s_add_u32 m0, m0, 4096
    s_nop 0
    buffer_load_dwordx4 v12, s[28:31], s40 offen offset:0 lds
    buffer_load_dwordx4 v13, s[28:31], s40 offen offset:1024 lds
    s_add_u32 s40, s40, 786432
    s_cmp_eq_u32 s40, 7864320
    s_cselect_b32 s40, 0, s40
    s_add_u32 m0, s44, 24576
    s_nop 0
    buffer_load_dwordx4 v14, s[32:35], s41 offen offset:0 lds
    buffer_load_dwordx4 v15, s[32:35], s41 offen offset:1024 lds
    buffer_load_dwordx4 v16, s[32:35], s41 offen offset:2048 lds
    s_add_u32 s41, s41, 128
    s_cmp_eq_u32 s41, 1280
    s_cselect_b32 s41, 0, s41
    s_cmp_lg_u32 s42, 4
    s_cbranch_scc1 KA_NK4
    s_add_u32 m0, s47, 110592
    s_nop 0
    buffer_load_dwordx4 v20, s[56:59], s25 offen offset:0 nt lds
    buffer_load_dwordx4 v21, s[56:59], s25 offen offset:1024 nt lds
    buffer_load_dwordx4 v22, s[56:59], s25 offen offset:2048 nt lds
    s_add_u32 s25, s25, 3072
    s_add_u32 m0, s47, 113664
    s_nop 0
    buffer_load_dwordx4 v23, s[56:59], s25 offen offset:0 nt lds
    buffer_load_dwordx4 v24, s[56:59], s25 offen offset:1024 nt lds
    buffer_load_dwordx4 v25, s[56:59], s25 offen offset:2048 nt lds
    s_add_u32 s25, s25, 3072
    s_add_u32 m0, s47, 116736
    s_nop 0
    buffer_load_dwordx4 v20, s[56:59], s25 offen offset:0 nt lds
    buffer_load_dwordx4 v21, s[56:59], s25 offen offset:1024 nt lds
    buffer_load_dwordx4 v22, s[56:59], s25 offen offset:2048 nt lds
KA_NK4:
    s_sub_u32 s26, 4, s42
    s_cmp_le_u32 s26, 1
    s_cbranch_scc1 KA_KX5
    s_waitcnt vmcnt(9)
KA_KX5:
    s_waitcnt vmcnt(18)
    s_barrier
    s_add_u32 m0, s43, 36864
    s_nop 0
    buffer_load_dwordx4 v8, s[28:31], s40 offen offset:0 lds
    buffer_load_dwordx4 v9, s[28:31], s40 offen offset:1024 lds
    buffer_load_dwordx4 v10, s[28:31], s40 offen offset:2048 lds
    buffer_load_dwordx4 v11, s[28:31], s40 offen offset:3072 lds
    s_add_u32 m0, m0, 4096
    s_nop 0
    buffer_load_dwordx4 v12, s[28:31], s40 offen offset:0 lds
    buffer_load_dwordx4 v13, s[28:31], s40 offen offset:1024 lds
    s_add_u32 s40, s40, 786432
    s_cmp_eq_u32 s40, 7864320
    s_cselect_b32 s40, 0, s40
    s_add_u32 m0, s44, 61440
    s_nop 0
    buffer_load_dwordx4 v14, s[32:35], s41 offen offset:0 lds
    buffer_load_dwordx4 v15, s[32:35], s41 offen offset:1024 lds
    buffer_load_dwordx4 v16, s[32:35], s41 offen offset:2048 lds
    s_add_u32 s41, s41, 128
    s_cmp_eq_u32 s41, 1280
    s_cselect_b32 s41, 0, s41
    s_cmp_lg_u32 s42, 5
    s_cbranch_scc1 KA_NK5
    s_add_u32 m0, s47, 110592
    s_nop 0
    buffer_load_dwordx4 v20, s[56:59], s25 offen offset:0 nt lds
    buffer_load_dwordx4 v21, s[56:59], s25 offen offset:1024 nt lds
    buffer_load_dwordx4 v22, s[56:59], s25 offen offset:2048 nt lds
    s_add_u32 s25, s25, 3072
    s_add_u32 m0, s47, 113664
    s_nop 0
    buffer_load_dwordx4 v23, s[56:59], s25 offen offset:0 nt lds
    buffer_load_dwordx4 v24, s[56:59], s25 offen offset:1024 nt lds
    buffer_load_dwordx4 v25, s[56:59], s25 offen offset:2048 nt lds
    s_add_u32 s25, s25, 3072
    s_add_u32 m0, s47, 116736
    s_nop 0
    buffer_load_dwordx4 v20, s[56:59], s25 offen offset:0 nt lds
    buffer_load_dwordx4 v21, s[56:59], s25 offen offset:1024 nt lds
    buffer_load_dwordx4 v22, s[56:59], s25 offen offset:2048 nt lds
KA_NK5:
    s_sub_u32 s26, 5, s42
    s_cmp_le_u32 s26, 1
    s_cbranch_scc1 KA_KX6
    s_waitcnt vmcnt(9)
KA_KX6:
    s_waitcnt vmcnt(18)
    s_barrier
    s_add_u32 m0, s43, 73728
    s_nop 0
    buffer_load_dwordx4 v8, s[28:31], s40 offen offset:0 lds
    buffer_load_dwordx4 v9, s[28:31], s40 offen offset:1024 lds
    buffer_load_dwordx4 v10, s[28:31], s40 offen offset:2048 lds
    buffer_load_dwordx4 v11, s[28:31], s40 offen offset:3072 lds
    s_add_u32 m0, m0, 4096
    s_nop 0
    buffer_load_dwordx4 v12, s[28:31], s40 offen offset:0 lds
    buffer_load_dwordx4 v13, s[28:31], s40 offen offset:1024 lds
    s_add_u32 s40, s40, 786432
    s_cmp_eq_u32 s40, 7864320
    s_cselect_b32 s40, 0, s40
    s_add_u32 m0, s44, 98304
    s_nop 0
    buffer_load_dwordx4 v14, s[32:35], s41 offen offset:0 lds
    buffer_load_dwordx4 v15, s[32:35], s41 offen offset:1024 lds
    buffer_load_dwordx4 v16, s[32:35], s41 offen offset:2048 lds
    s_add_u32 s41, s41, 128
    s_cmp_eq_u32 s41, 1280
    s_cselect_b32 s41, 0, s41
    s_cmp_lg_u32 s42, 6
    s_cbranch_scc1 KA_NK6
    s_add_u32 m0, s47, 110592
    s_nop 0
    buffer_load_dwordx4 v20, s[56:59], s25 offen offset:0 nt lds
    buffer_load_dwordx4 v21, s[56:59], s25 offen offset:1024 nt lds
    buffer_load_dwordx4 v22, s[56:59], s25 offen offset:2048 nt lds
    s_add_u32 s25, s25, 3072
    s_add_u32 m0, s47, 113664
    s_nop 0
    buffer_load_dwordx4 v23, s[56:59], s25 offen offset:0 nt lds
    buffer_load_dwordx4 v24, s[56:59], s25 offen offset:1024 nt lds
    buffer_load_dwordx4 v25, s[56:59], s25 offen offset:2048 nt lds
    s_add_u32 s25, s25, 3072
    s_add_u32 m0, s47, 116736
    s_nop 0
    buffer_load_dwordx4 v20, s[56:59], s25 offen offset:0 nt lds
    buffer_load_dwordx4 v21, s[56:59], s25 offen offset:1024 nt lds
    buffer_load_dwordx4 v22, s[56:59], s25 offen offset:2048 nt lds
KA_NK6:
    buffer_load_dword v54, v50, s[36:39], 0 offen sc1
    s_mov_b32 s28, s14
    s_mov_b32 s29, s15
    s_mov_b32 s30, 7864320
    s_mov_b32 s31, 0x00020000
    s_mov_b32 s32, s8
    s_mov_b32 s33, s9
    s_mov_b32 s34, 9437184
    s_mov_b32 s35, 0x00020000
    s_sub_u32 s26, 6, s42
    s_cmp_le_u32 s26, 1
    s_cbranch_scc1 KA_KX7
    s_waitcnt vmcnt(10)
KA_KX7:
    s_waitcnt vmcnt(19)
    s_barrier
    s_add_u32 s26, s52, 0
    s_sub_u32 s27, s26, 3
    s_cmp_ge_u32 s26, 3
    s_cselect_b32 s26, s27, s26
    s_mul_i32 s27, s48, 3
    s_add_u32 s27, s27, s26
    s_mul_i32 s40, s27, 81920
    s_mul_i32 s41, s48, 18432
    s_lshl_b32 s26, s26, 7
    s_add_u32 s41, s41, s26
    s_add_u32 m0, s44, 20480
    s_nop 0
    buffer_load_dwordx4 v26, s[32:35], s41 offen offset:0 lds
    buffer_load_dwordx4 v27, s[32:35], s41 offen offset:1024 lds
    buffer_load_dwordx4 v28, s[32:35], s41 offen offset:2048 lds
    s_add_u32 m0, s45, 0
    s_nop 0
    buffer_load_dwordx4 v30, s[28:31], s40 offen offset:0 lds
    buffer_load_dwordx4 v31, s[28:31], s40 offen offset:1024 lds
    buffer_load_dwordx4 v32, s[28:31], s40 offen offset:2048 lds
    buffer_load_dwordx4 v33, s[28:31], s40 offen offset:3072 lds
    s_add_u32 m0, s45, 4096
    s_nop 0
    buffer_load_dwordx4 v34, s[28:31], s40 offen offset:0 lds
    s_sub_u32 s26, 7, s42
    s_cmp_le_u32 s26, 1
    s_cbranch_scc1 KA_KX8
    s_waitcnt vmcnt(9)
KA_KX8:
    s_waitcnt vmcnt(18)
    s_barrier
    s_add_u32 s26, s52, 1
    s_sub_u32 s27, s26, 3
    s_cmp_ge_u32 s26, 3
    s_cselect_b32 s26, s27, s26
    s_mul_i32 s27, s48, 3
    s_add_u32 s27, s27, s26
    s_mul_i32 s40, s27, 81920
    s_mul_i32 s41, s48, 18432
    s_lshl_b32 s26, s26, 7
    s_add_u32 s41, s41, s26
    s_add_u32 m0, s44, 57344
    s_nop 0
    buffer_load_dwordx4 v26, s[32:35], s41 offen offset:0 lds
    buffer_load_dwordx4 v27, s[32:35], s41 offen offset:1024 lds
    buffer_load_dwordx4 v28, s[32:35], s41 offen offset:2048 lds
    s_add_u32 m0, s45, 36864
    s_nop 0
    buffer_load_dwordx4 v30, s[28:31], s40 offen offset:0 lds
    buffer_load_dwordx4 v31, s[28:31], s40 offen offset:1024 lds
    buffer_load_dwordx4 v32, s[28:31], s40 offen offset:2048 lds
    buffer_load_dwordx4 v33, s[28:31], s40 offen offset:3072 lds
    s_add_u32 m0, s45, 40960
    s_nop 0
    buffer_load_dwordx4 v34, s[28:31], s40 offen offset:0 lds
    s_waitcnt vmcnt(16)
    s_mov_b32 s26, 0
KA_RDY:
    v_cmp_ne_u32 vcc, 15, v54
    s_add_u32 s26, s26, 1
    s_cmp_eq_u64 vcc, 0
    s_cbranch_scc1 KA_RDYD
    s_cmp_gt_u32 s26, 4194304
    s_cbranch_scc1 KA_RDYD
    buffer_load_dword v54, v50, s[36:39], 0 offen sc1
    s_waitcnt vmcnt(0)
    s_branch KA_RDY
KA_RDYD:
    s_barrier
    s_add_u32 s26, s52, 2
    s_sub_u32 s27, s26, 3
    s_cmp_ge_u32 s26, 3
    s_cselect_b32 s26, s27, s26
    s_mul_i32 s27, s48, 3
    s_add_u32 s27, s27, s26
    s_mul_i32 s40, s27, 81920
    s_mul_i32 s41, s48, 18432
    s_lshl_b32 s26, s26, 7
    s_add_u32 s41, s41, s26
    s_add_u32 m0, s44, 94208
    s_nop 0
    buffer_load_dwordx4 v26, s[32:35], s41 offen offset:0 lds
    buffer_load_dwordx4 v27, s[32:35], s41 offen offset:1024 lds
    buffer_load_dwordx4 v28, s[32:35], s41 offen offset:2048 lds
    s_add_u32 m0, s45, 73728
    s_nop 0
    buffer_load_dwordx4 v30, s[28:31], s40 offen offset:0 lds
    buffer_load_dwordx4 v31, s[28:31], s40 offen offset:1024 lds
    buffer_load_dwordx4 v32, s[28:31], s40 offen offset:2048 lds
    buffer_load_dwordx4 v33, s[28:31], s40 offen offset:3072 lds
    s_add_u32 m0, s45, 77824
    s_nop 0
    buffer_load_dwordx4 v34, s[28:31], s40 offen offset:0 lds
    s_barrier
    s_waitcnt vmcnt(16)
    s_barrier
    s_add_u32 s26, s52, 0
    s_sub_u32 s27, s26, 3
    s_cmp_ge_u32 s26, 3
    s_cselect_b32 s26, s27, s26
    s_mul_i32 s27, s49, 3
    s_add_u32 s27, s27, s26
    s_mul_i32 s40, s27, 81920
    s_mul_i32 s41, s49, 18432
    s_lshl_b32 s26, s26, 7
    s_add_u32 s41, s41, s26
    s_add_u32 m0, s44, 131072
    s_nop 0
    buffer_load_dwordx4 v26, s[32:35], s41 offen offset:0 lds
    buffer_load_dwordx4 v27, s[32:35], s41 offen offset:1024 lds
    buffer_load_dwordx4 v28, s[32:35], s41 offen offset:2048 lds
    s_add_u32 m0, s45, 110592
    s_nop 0
    buffer_load_dwordx4 v30, s[28:31], s40 offen offset:0 lds
    buffer_load_dwordx4 v31, s[28:31], s40 offen offset:1024 lds
    buffer_load_dwordx4 v32, s[28:31], s40 offen offset:2048 lds
    buffer_load_dwordx4 v33, s[28:31], s40 offen offset:3072 lds
    s_add_u32 m0, s45, 114688
    s_nop 0
    buffer_load_dwordx4 v34, s[28:31], s40 offen offset:0 lds
    s_mov_b32 s4, s18
    s_mov_b32 s5, s19
    s_mov_b32 s6, 2359296
    s_mov_b32 s7, 0x00020000
    s_add_u32 s36, s18, 4194304
    s_addc_u32 s37, s19, 0
    s_mov_b32 s38, 589824
    s_mov_b32 s39, 0x00020000
    s_lshl_b32 s47, s24, 11
    s_lshl_b32 s25, s21, 5
    s_add_u32 s25, s25, s3
    s_waitcnt vmcnt(16)
    s_barrier
    s_add_u32 s26, s52, 1
    s_sub_u32 s27, s26, 3
    s_cmp_ge_u32 s26, 3
    s_cselect_b32 s26, s27, s26
    s_mul_i32 s27, s49, 3
    s_add_u32 s27, s27, s26
    s_mul_i32 s40, s27, 81920
    s_mul_i32 s41, s49, 18432
    s_lshl_b32 s26, s26, 7
    s_add_u32 s41, s41, s26
    s_add_u32 m0, s44, 20480
    s_nop 0
    buffer_load_dwordx4 v26, s[32:35], s41 offen offset:0 lds
    buffer_load_dwordx4 v27, s[32:35], s41 offen offset:1024 lds
    buffer_load_dwordx4 v28, s[32:35], s41 offen offset:2048 lds
    s_add_u32 m0, s45, 0
    s_nop 0
    buffer_load_dwordx4 v30, s[28:31], s40 offen offset:0 lds
    buffer_load_dwordx4 v31, s[28:31], s40 offen offset:1024 lds
    buffer_load_dwordx4 v32, s[28:31], s40 offen offset:2048 lds
    buffer_load_dwordx4 v33, s[28:31], s40 offen offset:3072 lds
    s_add_u32 m0, s45, 4096
    s_nop 0
    buffer_load_dwordx4 v34, s[28:31], s40 offen offset:0 lds
    s_waitcnt vmcnt(16)
    s_barrier
    s_add_u32 s26, s52, 2
    s_sub_u32 s27, s26, 3
    s_cmp_ge_u32 s26, 3
    s_cselect_b32 s26, s27, s26
    s_mul_i32 s27, s49, 3
    s_add_u32 s27, s27, s26
    s_mul_i32 s40, s27, 81920
    s_mul_i32 s41, s49, 18432
    s_lshl_b32 s26, s26, 7
    s_add_u32 s41, s41, s26
    s_add_u32 m0, s44, 57344
    s_nop 0
    buffer_load_dwordx4 v26, s[32:35], s41 offen offset:0 lds
    buffer_load_dwordx4 v27, s[32:35], s41 offen offset:1024 lds
    buffer_load_dwordx4 v28, s[32:35], s41 offen offset:2048 lds
    s_add_u32 m0, s45, 36864
    s_nop 0
    buffer_load_dwordx4 v30, s[28:31], s40 offen offset:0 lds
    buffer_load_dwordx4 v31, s[28:31], s40 offen offset:1024 lds
    buffer_load_dwordx4 v32, s[28:31], s40 offen offset:2048 lds
    buffer_load_dwordx4 v33, s[28:31], s40 offen offset:3072 lds
    s_add_u32 m0, s45, 40960
    s_nop 0
    buffer_load_dwordx4 v34, s[28:31], s40 offen offset:0 lds
    s_waitcnt vmcnt(16)
    s_barrier
    s_add_u32 s26, s52, 0
    s_sub_u32 s27, s26, 3
    s_cmp_ge_u32 s26, 3
    s_cselect_b32 s26, s27, s26
    s_mul_i32 s27, s50, 3
    s_add_u32 s27, s27, s26
    s_mul_i32 s40, s27, 81920
    s_mul_i32 s41, s50, 18432
    s_lshl_b32 s26, s26, 7
    s_add_u32 s41, s41, s26
    s_add_u32 m0, s44, 94208
    s_nop 0
    buffer_load_dwordx4 v26, s[32:35], s41 offen offset:0 lds
    buffer_load_dwordx4 v27, s[32:35], s41 offen offset:1024 lds
    buffer_load_dwordx4 v28, s[32:35], s41 offen offset:2048 lds
    s_add_u32 m0, s45, 73728
    s_nop 0
    buffer_load_dwordx4 v30, s[28:31], s40 offen offset:0 lds
    buffer_load_dwordx4 v31, s[28:31], s40 offen offset:1024 lds
    buffer_load_dwordx4 v32, s[28:31], s40 offen offset:2048 lds
    buffer_load_dwordx4 v33, s[28:31], s40 offen offset:3072 lds
    s_add_u32 m0, s45, 77824
    s_nop 0
    buffer_load_dwordx4 v34, s[28:31], s40 offen offset:0 lds
    s_waitcnt vmcnt(16)
    s_barrier
    s_add_u32 s26, s52, 1
    s_sub_u32 s27, s26, 3
    s_cmp_ge_u32 s26, 3
    s_cselect_b32 s26, s27, s26
    s_mul_i32 s27, s50, 3
    s_add_u32 s27, s27, s26
    s_mul_i32 s40, s27, 81920
    s_mul_i32 s41, s50, 18432
    s_lshl_b32 s26, s26, 7
    s_add_u32 s41, s41, s26
    s_add_u32 m0, s44, 131072
    s_nop 0
    buffer_load_dwordx4 v26, s[32:35], s41 offen offset:0 lds
    buffer_load_dwordx4 v27, s[32:35], s41 offen offset:1024 lds
    buffer_load_dwordx4 v28, s[32:35], s41 offen offset:2048 lds
    s_add_u32 m0, s45, 110592
    s_nop 0
    buffer_load_dwordx4 v30, s[28:31], s40 offen offset:0 lds
    buffer_load_dwordx4 v31, s[28:31], s40 offen offset:1024 lds
    buffer_load_dwordx4 v32, s[28:31], s40 offen offset:2048 lds
    buffer_load_dwordx4 v33, s[28:31], s40 offen offset:3072 lds
    s_add_u32 m0, s45, 114688
    s_nop 0
    buffer_load_dwordx4 v34, s[28:31], s40 offen offset:0 lds
    s_waitcnt vmcnt(16)
    s_barrier
    buffer_load_dword v54, v62, s[36:39], s46 offen sc1
    s_add_u32 s26, s52, 2
    s_sub_u32 s27, s26, 3
    s_cmp_ge_u32 s26, 3
    s_cselect_b32 s26, s27, s26
    s_mul_i32 s27, s50, 3
    s_add_u32 s27, s27, s26
    s_mul_i32 s40, s27, 81920
    s_mul_i32 s41, s50, 18432
    s_lshl_b32 s26, s26, 7
    s_add_u32 s41, s41, s26
    s_add_u32 m0, s44, 20480
    s_nop 0
    buffer_load_dwordx4 v26, s[32:35], s41 offen offset:0 lds
    buffer_load_dwordx4 v27, s[32:35], s41 offen offset:1024 lds
    buffer_load_dwordx4 v28, s[32:35], s41 offen offset:2048 lds
    s_add_u32 m0, s45, 0
    s_nop 0
    buffer_load_dwordx4 v30, s[28:31], s40 offen offset:0 lds
    buffer_load_dwordx4 v31, s[28:31], s40 offen offset:1024 lds
    buffer_load_dwordx4 v32, s[28:31], s40 offen offset:2048 lds
    buffer_load_dwordx4 v33, s[28:31], s40 offen offset:3072 lds
    s_add_u32 m0, s45, 4096
    s_nop 0
    buffer_load_dwordx4 v34, s[28:31], s40 offen offset:0 lds
    s_waitcnt vmcnt(17)
    s_barrier
    s_waitcnt vmcnt(8)
    s_mov_b32 s26, 0
KA_PPOLL:
    v_cmp_ne_u32 vcc, 1, v54
    s_add_u32 s26, s26, 1
    s_cmp_eq_u64 vcc, 0
    s_cbranch_scc1 KA_PPOLLD
    s_cmp_gt_u32 s26, 4194304
    s_cbranch_scc1 KA_PPOLLD
    buffer_load_dword v54, v62, s[36:39], s46 offen sc1
    s_waitcnt vmcnt(0)
    s_branch KA_PPOLL
KA_PPOLLD:
    s_lshl_b32 s26, s49, 3
    s_add_u32 s26, s26, s25
    s_mul_i32 s26, s26, 9216
    s_add_u32 s26, s26, s47
    s_add_u32 m0, s47, 143360
    s_cmp_lg_u32 s24, 3
    s_cbranch_scc1 KA_PT1
    buffer_load_dwordx4 v55, s[4:7], s26 offen offset:2048 sc1 lds
KA_PT1:
    buffer_load_dwordx4 v55, s[4:7], s26 offen offset:0 sc1 lds
    buffer_load_dwordx4 v55, s[4:7], s26 offen offset:1024 sc1 lds
    s_lshl_b32 s26, s50, 3
    s_add_u32 s26, s26, s25
    s_mul_i32 s26, s26, 9216
    s_add_u32 s26, s26, s47
    s_add_u32 m0, s47, 152576
    s_cmp_lg_u32 s24, 3
    s_cbranch_scc1 KA_PT2
    buffer_load_dwordx4 v55, s[4:7], s26 offen offset:2048 sc1 lds
KA_PT2:
    buffer_load_dwordx4 v55, s[4:7], s26 offen offset:0 sc1 lds
    buffer_load_dwordx4 v55, s[4:7], s26 offen offset:1024 sc1 lds
    s_add_u32 s26, s52, 0
    s_sub_u32 s27, s26, 3
    s_cmp_ge_u32 s26, 3
    s_cselect_b32 s26, s27, s26
    s_mul_i32 s27, s51, 3
    s_add_u32 s27, s27, s26
    s_mul_i32 s40, s27, 81920
    s_mul_i32 s41, s51, 18432
    s_lshl_b32 s26, s26, 7
    s_add_u32 s41, s41, s26
    s_add_u32 m0, s44, 57344
    s_nop 0
    buffer_load_dwordx4 v26, s[32:35], s41 offen offset:0 lds
    buffer_load_dwordx4 v27, s[32:35], s41 offen offset:1024 lds
    buffer_load_dwordx4 v28, s[32:35], s41 offen offset:2048 lds
    s_add_u32 m0, s45, 36864
    s_nop 0
    buffer_load_dwordx4 v30, s[28:31], s40 offen offset:0 lds
    buffer_load_dwordx4 v31, s[28:31], s40 offen offset:1024 lds
    buffer_load_dwordx4 v32, s[28:31], s40 offen offset:2048 lds
    buffer_load_dwordx4 v33, s[28:31], s40 offen offset:3072 lds
    s_add_u32 m0, s45, 40960
    s_nop 0
    buffer_load_dwordx4 v34, s[28:31], s40 offen offset:0 lds
    s_waitcnt vmcnt(21)
    s_waitcnt vmcnt(10)
    s_barrier
    s_add_u32 s26, s52, 1
    s_sub_u32 s27, s26, 3
    s_cmp_ge_u32 s26, 3
    s_cselect_b32 s26, s27, s26
    s_mul_i32 s27, s51, 3
    s_add_u32 s27, s27, s26
    s_mul_i32 s40, s27, 81920
    s_mul_i32 s41, s51, 18432
    s_lshl_b32 s26, s26, 7
    s_add_u32 s41, s41, s26
    s_add_u32 m0, s44, 94208
    s_nop 0
    buffer_load_dwordx4 v26, s[32:35], s41 offen offset:0 lds
    buffer_load_dwordx4 v27, s[32:35], s41 offen offset:1024 lds
    buffer_load_dwordx4 v28, s[32:35], s41 offen offset:2048 lds
    s_add_u32 m0, s45, 73728
    s_nop 0
    buffer_load_dwordx4 v30, s[28:31], s40 offen offset:0 lds
    buffer_load_dwordx4 v31, s[28:31], s40 offen offset:1024 lds
    buffer_load_dwordx4 v32, s[28:31], s40 offen offset:2048 lds
    buffer_load_dwordx4 v33, s[28:31], s40 offen offset:3072 lds
    s_add_u32 m0, s45, 77824
    s_nop 0
    buffer_load_dwordx4 v34, s[28:31], s40 offen offset:0 lds
    s_waitcnt vmcnt(20)
    s_barrier
    s_add_u32 s26, s52, 2
    s_sub_u32 s27, s26, 3
    s_cmp_ge_u32 s26, 3
    s_cselect_b32 s26, s27, s26
    s_mul_i32 s27, s51, 3
    s_add_u32 s27, s27, s26
    s_mul_i32 s40, s27, 81920
    s_mul_i32 s41, s51, 18432
    s_lshl_b32 s26, s26, 7
    s_add_u32 s41, s41, s26
    s_add_u32 m0, s44, 131072
    s_nop 0
    buffer_load_dwordx4 v26, s[32:35], s41 offen offset:0 lds
    buffer_load_dwordx4 v27, s[32:35], s41 offen offset:1024 lds
    buffer_load_dwordx4 v28, s[32:35], s41 offen offset:2048 lds
    s_add_u32 m0, s45, 110592
    s_nop 0
    buffer_load_dwordx4 v30, s[28:31], s40 offen offset:0 lds
    buffer_load_dwordx4 v31, s[28:31], s40 offen offset:1024 lds
    buffer_load_dwordx4 v32, s[28:31], s40 offen offset:2048 lds
    buffer_load_dwordx4 v33, s[28:31], s40 offen offset:3072 lds
    s_add_u32 m0, s45, 114688
    s_nop 0
    buffer_load_dwordx4 v34, s[28:31], s40 offen offset:0 lds
    s_waitcnt vmcnt(16)
    s_barrier
    s_lshl_b32 s26, s51, 3
    s_add_u32 s26, s26, s25
    s_mul_i32 s26, s26, 9216
    s_add_u32 s26, s26, s47
    s_add_u32 m0, s47, 143360
    s_cmp_lg_u32 s24, 3
    s_cbranch_scc1 KA_PT3
    buffer_load_dwordx4 v55, s[4:7], s26 offen offset:2048 sc1 lds
KA_PT3:
    buffer_load_dwordx4 v55, s[4:7], s26 offen offset:0 sc1 lds
    buffer_load_dwordx4 v55, s[4:7], s26 offen offset:1024 sc1 lds
    s_load_dwordx2 s[10:11], s[0:1], 40
    s_lshl_b32 s26, s24, 6
    v_add_u32 v1, s26, v0
    v_cmp_le_u32 vcc, 120, v1
    s_nop 1
    v_cndmask_b32 v2, 0, 1, vcc
    v_mul_u32_u24 v3, 120, v2
    v_sub_u32 v3, v1, v3
    v_cmp_le_u32 vcc, 48, v3
    s_nop 1
    v_cndmask_b32 v4, 0, 1, vcc
    v_mul_u32_u24 v5, 48, v4
    v_sub_u32 v5, v3, v5
    v_lshrrev_b32 v6, 2, v5
    v_and_b32 v7, 3, v5
    v_subrev_u32 v60, 96, v3
    v_lshrrev_b32 v61, 1, v60
    v_and_b32 v59, 1, v60
    v_cmp_le_u32 vcc, 96, v3
    s_nop 1
    v_cndmask_b32 v6, v6, v61, vcc
    v_cndmask_b32 v7, v7, v59, vcc
    v_cndmask_b32 v4, v4, 2, vcc
    v_cndmask_b32 v63, 6, 5, vcc
    s_mul_i32 s26, s3, 12
    v_add_u32 v6, s26, v6
    v_lshrrev_b32 v60, 4, v6
    v_and_b32 v61, 15, v6
    v_lshlrev_b32 v61, v63, v61
    v_lshl_add_u32 v61, v4, 10, v61
    v_lshl_add_u32 v61, v7, 4, v61
    v_lshl_add_u32 v60, v60, 3, v2
    s_mul_i32 s26, s21, 48
    s_lshl_b32 s27, s22, 1
    s_add_u32 s26, s26, s27
    v_add_u32 v60, s26, v60
    v_mul_u32_u24 v60, 20480, v60
    v_add_u32 v60, v60, v61
    s_mul_i32 s26, s21, 96
    v_add_u32 v6, s26, v6
    v_mul_u32_u24 v6, 1280, v6
    v_mul_u32_u24 v2, 160, v2
    v_lshl_add_u32 v2, v4, 6, v2
    v_lshl_add_u32 v2, v7, 4, v2
    s_mul_i32 s26, s22, 320
    v_add3_u32 v61, v6, v2, s26
    v_mov_b32 v2, 2147483392
    v_cmp_gt_u32 vcc, 240, v1
    s_nop 1
    v_cndmask_b32 v60, v2, v60, vcc
    v_cndmask_b32 v61, v2, v61, vcc
    s_waitcnt vmcnt(10)
    s_waitcnt vmcnt(26)
    s_barrier
    s_waitcnt vmcnt(2)
    s_waitcnt vmcnt(0)
    s_barrier
    s_waitcnt lgkmcnt(0)
    s_add_u32 s28, s18, 16777216
    s_addc_u32 s29, s19, 0
    s_mov_b32 s30, 7864320
    s_mov_b32 s31, 0x00020000
    s_mov_b32 s32, s10
    s_mov_b32 s33, s11
    s_mov_b32 s34, 983040
    s_mov_b32 s35, 0x00020000
    s_mov_b32 s26, 0
    s_mov_b32 s24, 0xffff0000
    v_mov_b32 v2, 2147483392
    v_cmp_gt_u32 vcc, 1, v0
    s_nop 1
    v_cndmask_b32 v38, v2, v62, vcc
    s_mov_b32 s25, 0
KA_FPOLL:
    v_mov_b32 v54, 0
    buffer_atomic_or v54, v38, s[36:39], s46 offen offset:128 sc0
    s_add_u32 s26, s26, 1
    s_waitcnt vmcnt(0)
    v_readfirstlane_b32 s27, v54
    s_cmp_gt_u32 s26, 4194304
    s_cselect_b32 s27, 0xffff, s27
    s_lshr_b32 s40, s27, 1
    s_and_b32 s27, s27, s40
    s_and_b32 s27, s27, 0x5555
    s_andn2_b32 s27, s27, s25
    s_cbranch_scc0 KA_FPOLL
    s_or_b32 s25, s25, s27
    s_bitcmp1_b32 s27, 0
    s_cbranch_scc0 KA_FS0
    s_mov_b32 s40, 0
    buffer_load_dwordx4 v[64:67], v60, s[28:31], s40 offen sc1
KA_FS0:
    s_bitcmp1_b32 s27, 2
    s_cbranch_scc0 KA_FS1
    s_mov_b32 s40, 2560
    buffer_load_dwordx4 v[68:71], v60, s[28:31], s40 offen sc1
KA_FS1:
    s_bitcmp1_b32 s27, 4
    s_cbranch_scc0 KA_FS2
    s_mov_b32 s40, 5120
    buffer_load_dwordx4 v[72:75], v60, s[28:31], s40 offen sc1
KA_FS2:
    s_bitcmp1_b32 s27, 6
    s_cbranch_scc0 KA_FS3
    s_mov_b32 s40, 7680
    buffer_load_dwordx4 v[76:79], v60, s[28:31], s40 offen sc1
KA_FS3:
    s_bitcmp1_b32 s27, 8
    s_cbranch_scc0 KA_FS4
    s_mov_b32 s40, 10240
    buffer_load_dwordx4 v[80:83], v60, s[28:31], s40 offen sc1
KA_FS4:
    s_bitcmp1_b32 s27, 10
    s_cbranch_scc0 KA_FS5
    s_mov_b32 s40, 12800
    buffer_load_dwordx4 v[84:87], v60, s[28:31], s40 offen sc1
KA_FS5:
    s_bitcmp1_b32 s27, 12
    s_cbranch_scc0 KA_FS6
    s_mov_b32 s40, 15360
    buffer_load_dwordx4 v[88:91], v60, s[28:31], s40 offen sc1
KA_FS6:
    s_bitcmp1_b32 s27, 14
    s_cbranch_scc0 KA_FS7
    s_mov_b32 s40, 17920
    buffer_load_dwordx4 v[92:95], v60, s[28:31], s40 offen sc1
KA_FS7:
    s_cmp_lg_u32 s25, 0x5555
    s_cbranch_scc1 KA_FPOLL
    s_waitcnt vmcnt(0)
    v_lshlrev_b32 v100, 16, v64
    v_and_b32 v101, s24, v64
    v_lshlrev_b32 v102, 16, v65
    v_and_b32 v103, s24, v65
    v_lshlrev_b32 v104, 16, v66
    v_and_b32 v105, s24, v66
    v_lshlrev_b32 v106, 16, v67
    v_and_b32 v107, s24, v67
    v_lshlrev_b32 v108, 16, v68
    v_and_b32 v109, s24, v68
    v_pk_add_f32 v[100:101], v[100:101], v[108:109]
    v_lshlrev_b32 v110, 16, v69
    v_and_b32 v111, s24, v69
    v_pk_add_f32 v[102:103], v[102:103], v[110:111]
    v_lshlrev_b32 v112, 16, v70
    v_and_b32 v113, s24, v70
    v_pk_add_f32 v[104:105], v[104:105], v[112:113]
    v_lshlrev_b32 v114, 16, v71
    v_and_b32 v115, s24, v71
    v_pk_add_f32 v[106:107], v[106:107], v[114:115]
    v_lshlrev_b32 v108, 16, v72
    v_and_b32 v109, s24, v72
    v_pk_add_f32 v[100:101], v[100:101], v[108:109]
    v_lshlrev_b32 v110, 16, v73
    v_and_b32 v111, s24, v73
    v_pk_add_f32 v[102:103], v[102:103], v[110:111]
    v_lshlrev_b32 v112, 16, v74
    v_and_b32 v113, s24, v74
    v_pk_add_f32 v[104:105], v[104:105], v[112:113]
    v_lshlrev_b32 v114, 16, v75
    v_and_b32 v115, s24, v75
    v_pk_add_f32 v[106:107], v[106:107], v[114:115]
    v_lshlrev_b32 v108, 16, v76
    v_and_b32 v109, s24, v76
    v_pk_add_f32 v[100:101], v[100:101], v[108:109]
    v_lshlrev_b32 v110, 16, v77
    v_and_b32 v111, s24, v77
    v_pk_add_f32 v[102:103], v[102:103], v[110:111]
    v_lshlrev_b32 v112, 16, v78
    v_and_b32 v113, s24, v78
    v_pk_add_f32 v[104:105], v[104:105], v[112:113]
    v_lshlrev_b32 v114, 16, v79
    v_and_b32 v115, s24, v79
    v_pk_add_f32 v[106:107], v[106:107], v[114:115]
    v_lshlrev_b32 v108, 16, v80
    v_and_b32 v109, s24, v80
    v_pk_add_f32 v[100:101], v[100:101], v[108:109]
    v_lshlrev_b32 v110, 16, v81
    v_and_b32 v111, s24, v81
    v_pk_add_f32 v[102:103], v[102:103], v[110:111]
    v_lshlrev_b32 v112, 16, v82
    v_and_b32 v113, s24, v82
    v_pk_add_f32 v[104:105], v[104:105], v[112:113]
    v_lshlrev_b32 v114, 16, v83
    v_and_b32 v115, s24, v83
    v_pk_add_f32 v[106:107], v[106:107], v[114:115]
    v_lshlrev_b32 v108, 16, v84
    v_and_b32 v109, s24, v84
    v_pk_add_f32 v[100:101], v[100:101], v[108:109]
    v_lshlrev_b32 v110, 16, v85
    v_and_b32 v111, s24, v85
    v_pk_add_f32 v[102:103], v[102:103], v[110:111]
    v_lshlrev_b32 v112, 16, v86
    v_and_b32 v113, s24, v86
    v_pk_add_f32 v[104:105], v[104:105], v[112:113]
    v_lshlrev_b32 v114, 16, v87
    v_and_b32 v115, s24, v87
    v_pk_add_f32 v[106:107], v[106:107], v[114:115]
    v_lshlrev_b32 v108, 16, v88
    v_and_b32 v109, s24, v88
    v_pk_add_f32 v[100:101], v[100:101], v[108:109]
    v_lshlrev_b32 v110, 16, v89
    v_and_b32 v111, s24, v89
    v_pk_add_f32 v[102:103], v[102:103], v[110:111]
    v_lshlrev_b32 v112, 16, v90
    v_and_b32 v113, s24, v90
    v_pk_add_f32 v[104:105], v[104:105], v[112:113]
    v_lshlrev_b32 v114, 16, v91
    v_and_b32 v115, s24, v91
    v_pk_add_f32 v[106:107], v[106:107], v[114:115]
    v_lshlrev_b32 v108, 16, v92
    v_and_b32 v109, s24, v92
    v_pk_add_f32 v[100:101], v[100:101], v[108:109]
    v_lshlrev_b32 v110, 16, v93
    v_and_b32 v111, s24, v93
    v_pk_add_f32 v[102:103], v[102:103], v[110:111]
    v_lshlrev_b32 v112, 16, v94
    v_and_b32 v113, s24, v94
    v_pk_add_f32 v[104:105], v[104:105], v[112:113]
    v_lshlrev_b32 v114, 16, v95
    v_and_b32 v115, s24, v95
    v_pk_add_f32 v[106:107], v[106:107], v[114:115]
    v_cvt_pk_bf16_f32 v4, v100, v101
    v_cvt_pk_bf16_f32 v5, v102, v103
    v_cvt_pk_bf16_f32 v6, v104, v105
    v_cvt_pk_bf16_f32 v7, v106, v107
    buffer_store_dwordx4 v[4:7], v61, s[32:35], 0 offen
    s_endpgm
KA_COMPUTE:
    s_setprio 1
    s_and_b32 s24, s23, 1
    s_bfe_u32 s25, s23, 0x10001
    s_and_b32 s51, s23, 3
    v_lshrrev_b32 v2, 4, v0
    v_and_b32 v3, 15, v0
    v_bfe_u32 v5, v0, 2, 2
    v_and_b32 v6, 3, v0
    v_lshl_add_u32 v4, v2, 3, v5
    v_mul_u32_u24 v7, 384, v4
    v_lshl_add_u32 v7, v6, 3, v7
    v_add_u32 v7, 73728, v7
    v_lshrrev_b32 v12, 1, v5
    v_and_b32 v13, 1, v2
    v_lshl_or_b32 v12, v13, 1, v12
    s_mul_i32 s36, s25, 6
    s_add_u32 s37, s36, 0
    v_xor_b32 v16, s37, v12
    v_lshl_add_u32 v8, v16, 5, v7
    s_add_u32 s37, s36, 1
    v_xor_b32 v16, s37, v12
    v_lshl_add_u32 v9, v16, 5, v7
    s_add_u32 s37, s36, 2
    v_xor_b32 v16, s37, v12
    v_lshl_add_u32 v10, v16, 5, v7
    s_add_u32 s37, s36, 3
    v_xor_b32 v16, s37, v12
    v_lshl_add_u32 v11, v16, 5, v7
    v_mul_u32_u24 v7, 320, v4
    v_lshl_add_u32 v7, v6, 3, v7
    s_mul_i32 s36, s25, 5
    s_add_u32 s37, s36, 0
    v_xor_b32 v16, s37, v13
    v_lshl_add_u32 v248, v16, 5, v7
    s_add_u32 s37, s36, 1
    v_xor_b32 v16, s37, v13
    v_lshl_add_u32 v249, v16, 5, v7
    v_bfe_u32 v12, v3, 1, 3
    v_xor_b32 v12, v12, v2
    s_mul_i32 s36, s24, 6144
    s_add_u32 s36, s36, 98304
    v_lshlrev_b32 v16, 7, v3
    v_add_u32 v16, s36, v16
    v_lshl_add_u32 v14, v12, 4, v16
    v_xor_b32 v15, 64, v14
    v_subrev_u32 v250, 77824, v14
    v_subrev_u32 v251, 77824, v15
    v_lshlrev_b32 v12, 1, v13
    v_lshrrev_b32 v16, 1, v2
    v_or_b32 v12, v12, v16
    v_lshlrev_b32 v254, 6, v3
    v_lshl_add_u32 v254, v12, 4, v254
    v_lshlrev_b32 v255, 5, v3
    v_lshl_add_u32 v255, v2, 3, v255
    v_bfe_u32 v13, v3, 2, 1
    v_and_b32 v16, 2, v3
    v_or_b32 v13, v13, v16
    v_bfe_u32 v16, v3, 3, 1
    v_lshl_or_b32 v13, v16, 2, v13
    v_xor_b32 v12, v12, v13
    v_mul_u32_u24 v16, 384, v3
    s_mul_i32 s26, s24, 18432
    s_add_u32 s27, s26, 110592
    v_add_u32 v16, s27, v16
    s_mul_i32 s36, s25, 12
    s_sub_u32 s39, 12, s36
    s_add_u32 s37, s36, 0
    v_xor_b32 v13, s37, v12
    v_lshl_add_u32 v24, v13, 4, v16
    s_add_u32 s37, s39, 0
    v_xor_b32 v13, s37, v12
    v_lshl_add_u32 v20, v13, 4, v16
    s_add_u32 s37, s36, 4
    v_xor_b32 v13, s37, v12
    v_lshl_add_u32 v25, v13, 4, v16
    s_add_u32 s37, s39, 4
    v_xor_b32 v13, s37, v12
    v_lshl_add_u32 v21, v13, 4, v16
    s_add_u32 s37, s36, 8
    v_xor_b32 v13, s37, v12
    v_lshl_add_u32 v26, v13, 4, v16
    s_add_u32 s37, s39, 8
    v_xor_b32 v13, s37, v12
    v_lshl_add_u32 v22, v13, 4, v16
    v_lshlrev_b32 v252, 4, v0
    v_lshlrev_b32 v253, 3, v0
    v_mov_b32 v17, 2147483392
    v_cmp_gt_u32 vcc, 4, v0
    s_lshl_b32 s36, s21, 5
    s_add_u32 s36, s36, s3
    s_lshl_b32 s36, s36, 8
    s_lshl_b32 s37, s22, 4
    s_add_u32 s36, s36, s37
    s_lshl_b32 s37, s51, 2
    s_add_u32 s36, s36, s37
    v_lshlrev_b32 v16, 11, v0
    v_add_u32 v16, s36, v16
    v_cndmask_b32 v1, v17, v16, vcc
    s_andn2_b32 s36, s2, 7
    s_lshl_b32 s37, s24, 2
    s_add_u32 s36, s36, s37
    s_lshl_b32 s36, s36, 8
    s_add_u32 s36, s36, 128
    v_lshlrev_b32 v16, 8, v0
    v_add_u32 v16, s36, v16
    v_cndmask_b32 v2, v17, v16, vcc
    v_mov_b32 v3, 1
    s_mul_i32 s45, s24, 1536
    s_sub_u32 s45, 6144, s45
    s_mul_i32 s36, s24, 3072
    s_mul_i32 s48, s2, 9216
    s_add_u32 s48, s48, s36
    s_add_u32 s50, s48, s45
    s_add_u32 s36, s36, 152576
    v_add_u32 v4, s36, v252
    s_add_u32 s36, s36, s45
    v_add_u32 v5, s36, v253
    v_mov_b64 v[32:33], 0
    v_mov_b64 v[34:35], 0
    v_mov_b64 v[36:37], 0
    v_mov_b64 v[38:39], 0
    v_mov_b64 v[40:41], 0
    v_mov_b64 v[42:43], 0
    v_mov_b64 v[44:45], 0
    v_mov_b64 v[46:47], 0
    v_mov_b64 v[48:49], 0
    v_mov_b64 v[50:51], 0
    v_mov_b64 v[52:53], 0
    v_mov_b64 v[54:55], 0
    v_mov_b64 v[56:57], 0
    v_mov_b64 v[58:59], 0
    v_mov_b64 v[60:61], 0
    v_mov_b64 v[62:63], 0
    v_mov_b64 v[64:65], 0
    v_mov_b64 v[66:67], 0
    v_mov_b64 v[68:69], 0
    v_mov_b64 v[70:71], 0
    v_mov_b64 v[72:73], 0
    v_mov_b64 v[74:75], 0
    v_mov_b64 v[76:77], 0
    v_mov_b64 v[78:79], 0
    v_mov_b64 v[80:81], 0
    v_mov_b64 v[82:83], 0
    v_mov_b64 v[84:85], 0
    v_mov_b64 v[86:87], 0
    v_mov_b64 v[88:89], 0
    v_mov_b64 v[90:91], 0
    v_mov_b64 v[92:93], 0
    v_mov_b64 v[94:95], 0
    v_mov_b64 v[96:97], 0
    v_mov_b64 v[98:99], 0
    v_mov_b64 v[100:101], 0
    v_mov_b64 v[102:103], 0
    s_mov_b32 s38, 0
    s_mov_b32 s41, 36864
    s_mov_b32 s42, 1037384597
    s_mov_b32 s43, 1037384597
    s_mov_b32 s44, 0
    s_mul_i32 s37, s21, 6
    s_add_u32 s44, s44, s37
    s_mul_i32 s37, s24, 3
    s_add_u32 s44, s44, s37
    s_lshl_b32 s44, s44, 3
    s_lshl_b32 s37, s22, 1
    s_add_u32 s44, s44, s37
    s_add_u32 s44, s44, s25
    s_lshl_b32 s44, s44, 3
    s_add_u32 s44, s44, s3
    s_mul_i32 s44, s44, 2560
    s_mov_b32 s40, 0
    s_mov_b32 s46, 2
    s_mov_b32 s47, 1
    s_mov_b32 s49, 4294958080
    s_waitcnt lgkmcnt(0)
    s_mov_b32 s12, s18
    s_mov_b32 s13, s19
    s_mov_b32 s28, s18
    s_mov_b32 s29, s19
    s_mov_b32 s30, 2359296
    s_mov_b32 s31, 0x00020000
    s_add_u32 s32, s18, 16777216
    s_addc_u32 s33, s19, 0
    s_mov_b32 s34, 7864320
    s_mov_b32 s35, 0x00020000
    s_add_u32 s4, s18, 4194304
    s_addc_u32 s5, s19, 0
    s_mov_b32 s6, 589824
    s_mov_b32 s7, 0x00020000
    s_barrier
    ds_read_b128 v[152:155], v14 offset:0
    ds_read_b64_tr_b16 v[104:105], v8 offset:0
    ds_read_b64_tr_b16 v[106:107], v8 offset:1536
    ds_read_b128 v[156:159], v14 offset:2048
    ds_read_b128 v[160:163], v14 offset:4096
    ds_read_b64_tr_b16 v[108:109], v9 offset:0
    ds_read_b64_tr_b16 v[110:111], v9 offset:1536
    ds_read_b64_tr_b16 v[112:113], v10 offset:0
    ds_read_b64_tr_b16 v[114:115], v10 offset:1536
    ds_read_b64_tr_b16 v[116:117], v11 offset:0
    ds_read_b64_tr_b16 v[118:119], v11 offset:1536
    ds_read_b64_tr_b16 v[120:121], v8 offset:128
    ds_read_b64_tr_b16 v[122:123], v8 offset:1664
    ds_read_b64_tr_b16 v[124:125], v9 offset:128
    ds_read_b64_tr_b16 v[126:127], v9 offset:1664
KA_LOOP:
    s_waitcnt lgkmcnt(8)
    v_mfma_f32_16x16x32_bf16 v[32:35], v[104:107], v[152:155], v[32:35]
    ds_read_b128 v[164:167], v15 offset:0
    v_mfma_f32_16x16x32_bf16 v[36:39], v[104:107], v[156:159], v[36:39]
    ds_read_b64_tr_b16 v[128:129], v8 offset:12288
    v_mfma_f32_16x16x32_bf16 v[40:43], v[104:107], v[160:163], v[40:43]
    ds_read_b64_tr_b16 v[130:131], v8 offset:13824
    v_mfma_f32_16x16x32_bf16 v[44:47], v[108:111], v[152:155], v[44:47]
    ds_read_b128 v[168:171], v15 offset:2048
    s_add_u32 s38, s38, 1
    v_mfma_f32_16x16x32_bf16 v[48:51], v[108:111], v[156:159], v[48:51]
    ds_read_b128 v[172:175], v15 offset:4096
    s_add_u32 s46, s46, 1
    v_mfma_f32_16x16x32_bf16 v[52:55], v[108:111], v[160:163], v[52:55]
    ds_read_b64_tr_b16 v[132:133], v9 offset:12288
    s_cmp_eq_u32 s46, 3
    s_waitcnt lgkmcnt(10)
    v_mfma_f32_16x16x32_bf16 v[56:59], v[112:115], v[152:155], v[56:59]
    ds_read_b64_tr_b16 v[134:135], v9 offset:13824
    s_cselect_b32 s39, 4294893568, s41
    v_mfma_f32_16x16x32_bf16 v[60:63], v[112:115], v[156:159], v[60:63]
    ds_read_b64_tr_b16 v[136:137], v10 offset:12288
    s_cselect_b32 s46, 0, s46
    v_mfma_f32_16x16x32_bf16 v[64:67], v[112:115], v[160:163], v[64:67]
    ds_read_b64_tr_b16 v[138:139], v10 offset:13824
    v_mfma_f32_16x16x32_bf16 v[68:71], v[116:119], v[152:155], v[68:71]
    ds_read_b64_tr_b16 v[140:141], v11 offset:12288
    v_mfma_f32_16x16x32_bf16 v[72:75], v[116:119], v[156:159], v[72:75]
    ds_read_b64_tr_b16 v[142:143], v11 offset:13824
    v_mfma_f32_16x16x32_bf16 v[76:79], v[116:119], v[160:163], v[76:79]
    ds_read_b64_tr_b16 v[144:145], v8 offset:12416
    s_waitcnt lgkmcnt(12)
    v_mfma_f32_16x16x32_bf16 v[80:83], v[120:123], v[152:155], v[80:83]
    ds_read_b64_tr_b16 v[146:147], v8 offset:13952
    v_mfma_f32_16x16x32_bf16 v[84:87], v[120:123], v[156:159], v[84:87]
    ds_read_b64_tr_b16 v[148:149], v9 offset:12416
    v_mfma_f32_16x16x32_bf16 v[88:91], v[120:123], v[160:163], v[88:91]
    ds_read_b64_tr_b16 v[150:151], v9 offset:13952
    v_mfma_f32_16x16x32_bf16 v[92:95], v[124:127], v[152:155], v[92:95]
    v_add_u32 v14, s39, v14
    v_add_u32 v15, s39, v15
    v_mfma_f32_16x16x32_bf16 v[96:99], v[124:127], v[156:159], v[96:99]
    v_add_u32 v8, s39, v8
    v_add_u32 v9, s39, v9
    v_mfma_f32_16x16x32_bf16 v[100:103], v[124:127], v[160:163], v[100:103]
    v_add_u32 v10, s39, v10
    v_add_u32 v11, s39, v11
    s_waitcnt lgkmcnt(10)
    v_mfma_f32_16x16x32_bf16 v[32:35], v[128:131], v[164:167], v[32:35]
    v_mfma_f32_16x16x32_bf16 v[36:39], v[128:131], v[168:171], v[36:39]
    s_cmp_lt_u32 s38, 9
    v_mfma_f32_16x16x32_bf16 v[40:43], v[128:131], v[172:175], v[40:43]
    s_waitcnt lgkmcnt(0)
    s_barrier
    v_mfma_f32_16x16x32_bf16 v[44:47], v[132:135], v[164:167], v[44:47]
    ds_read_b128 v[152:155], v14 offset:0
    v_mfma_f32_16x16x32_bf16 v[48:51], v[132:135], v[168:171], v[48:51]
    ds_read_b64_tr_b16 v[104:105], v8 offset:0
    v_mfma_f32_16x16x32_bf16 v[52:55], v[132:135], v[172:175], v[52:55]
    ds_read_b64_tr_b16 v[106:107], v8 offset:1536
    v_mfma_f32_16x16x32_bf16 v[56:59], v[136:139], v[164:167], v[56:59]
    ds_read_b128 v[156:159], v14 offset:2048
    v_mfma_f32_16x16x32_bf16 v[60:63], v[136:139], v[168:171], v[60:63]
    ds_read_b128 v[160:163], v14 offset:4096
    v_mfma_f32_16x16x32_bf16 v[64:67], v[136:139], v[172:175], v[64:67]
    ds_read_b64_tr_b16 v[108:109], v9 offset:0
    v_mfma_f32_16x16x32_bf16 v[68:71], v[140:143], v[164:167], v[68:71]
    ds_read_b64_tr_b16 v[110:111], v9 offset:1536
    v_mfma_f32_16x16x32_bf16 v[72:75], v[140:143], v[168:171], v[72:75]
    ds_read_b64_tr_b16 v[112:113], v10 offset:0
    v_mfma_f32_16x16x32_bf16 v[76:79], v[140:143], v[172:175], v[76:79]
    ds_read_b64_tr_b16 v[114:115], v10 offset:1536
    v_mfma_f32_16x16x32_bf16 v[80:83], v[144:147], v[164:167], v[80:83]
    ds_read_b64_tr_b16 v[116:117], v11 offset:0
    v_mfma_f32_16x16x32_bf16 v[84:87], v[144:147], v[168:171], v[84:87]
    ds_read_b64_tr_b16 v[118:119], v11 offset:1536
    v_mfma_f32_16x16x32_bf16 v[88:91], v[144:147], v[172:175], v[88:91]
    ds_read_b64_tr_b16 v[120:121], v8 offset:128
    v_mfma_f32_16x16x32_bf16 v[92:95], v[148:151], v[164:167], v[92:95]
    ds_read_b64_tr_b16 v[122:123], v8 offset:1664
    v_mfma_f32_16x16x32_bf16 v[96:99], v[148:151], v[168:171], v[96:99]
    ds_read_b64_tr_b16 v[124:125], v9 offset:128
    v_mfma_f32_16x16x32_bf16 v[100:103], v[148:151], v[172:175], v[100:103]
    ds_read_b64_tr_b16 v[126:127], v9 offset:1664
    s_cbranch_scc1 KA_LOOP
    s_waitcnt lgkmcnt(8)
    v_mfma_f32_16x16x32_bf16 v[32:35], v[104:107], v[152:155], v[32:35]
    ds_read_b128 v[164:167], v15 offset:0
    v_mfma_f32_16x16x32_bf16 v[36:39], v[104:107], v[156:159], v[36:39]
    ds_read_b64_tr_b16 v[128:129], v8 offset:12288
    v_mfma_f32_16x16x32_bf16 v[40:43], v[104:107], v[160:163], v[40:43]
    ds_read_b64_tr_b16 v[130:131], v8 offset:13824
    v_mfma_f32_16x16x32_bf16 v[44:47], v[108:111], v[152:155], v[44:47]
    ds_read_b128 v[168:171], v15 offset:2048
    s_add_u32 s38, s38, 1
    v_mfma_f32_16x16x32_bf16 v[48:51], v[108:111], v[156:159], v[48:51]
    ds_read_b128 v[172:175], v15 offset:4096
    s_add_u32 s46, s46, 1
    v_mfma_f32_16x16x32_bf16 v[52:55], v[108:111], v[160:163], v[52:55]
    ds_read_b64_tr_b16 v[132:133], v9 offset:12288
    s_cmp_eq_u32 s46, 3
    s_waitcnt lgkmcnt(10)
    v_mfma_f32_16x16x32_bf16 v[56:59], v[112:115], v[152:155], v[56:59]
    ds_read_b64_tr_b16 v[134:135], v9 offset:13824
    s_cselect_b32 s39, 4294893568, s41
    v_mfma_f32_16x16x32_bf16 v[60:63], v[112:115], v[156:159], v[60:63]
    ds_read_b64_tr_b16 v[136:137], v10 offset:12288
    s_cselect_b32 s46, 0, s46
    v_mfma_f32_16x16x32_bf16 v[64:67], v[112:115], v[160:163], v[64:67]
    ds_read_b64_tr_b16 v[138:139], v10 offset:13824
    v_mfma_f32_16x16x32_bf16 v[68:71], v[116:119], v[152:155], v[68:71]
    ds_read_b64_tr_b16 v[140:141], v11 offset:12288
    v_mfma_f32_16x16x32_bf16 v[72:75], v[116:119], v[156:159], v[72:75]
    ds_read_b64_tr_b16 v[142:143], v11 offset:13824
    v_mfma_f32_16x16x32_bf16 v[76:79], v[116:119], v[160:163], v[76:79]
    ds_read_b64_tr_b16 v[144:145], v8 offset:12416
    s_waitcnt lgkmcnt(12)
    v_mfma_f32_16x16x32_bf16 v[80:83], v[120:123], v[152:155], v[80:83]
    ds_read_b64_tr_b16 v[146:147], v8 offset:13952
    v_mfma_f32_16x16x32_bf16 v[84:87], v[120:123], v[156:159], v[84:87]
    ds_read_b64_tr_b16 v[148:149], v9 offset:12416
    v_mfma_f32_16x16x32_bf16 v[88:91], v[120:123], v[160:163], v[88:91]
    ds_read_b64_tr_b16 v[150:151], v9 offset:13952
    v_mfma_f32_16x16x32_bf16 v[92:95], v[124:127], v[152:155], v[92:95]
    v_add_u32 v14, s39, v14
    v_add_u32 v15, s39, v15
    v_mfma_f32_16x16x32_bf16 v[96:99], v[124:127], v[156:159], v[96:99]
    v_add_u32 v8, s39, v8
    v_add_u32 v9, s39, v9
    v_mfma_f32_16x16x32_bf16 v[100:103], v[124:127], v[160:163], v[100:103]
    v_add_u32 v10, s39, v10
    v_add_u32 v11, s39, v11
    s_waitcnt lgkmcnt(8)
    v_mfma_f32_16x16x32_bf16 v[32:35], v[128:131], v[164:167], v[32:35]
    v_mfma_f32_16x16x32_bf16 v[36:39], v[128:131], v[168:171], v[36:39]
    v_mfma_f32_16x16x32_bf16 v[40:43], v[128:131], v[172:175], v[40:43]
    v_mfma_f32_16x16x32_bf16 v[44:47], v[132:135], v[164:167], v[44:47]
    v_mfma_f32_16x16x32_bf16 v[48:51], v[132:135], v[168:171], v[48:51]
    v_mfma_f32_16x16x32_bf16 v[52:55], v[132:135], v[172:175], v[52:55]
    s_waitcnt lgkmcnt(0)
    v_mfma_f32_16x16x32_bf16 v[56:59], v[136:139], v[164:167], v[56:59]
    v_mfma_f32_16x16x32_bf16 v[60:63], v[136:139], v[168:171], v[60:63]
    v_mfma_f32_16x16x32_bf16 v[64:67], v[136:139], v[172:175], v[64:67]
    v_mfma_f32_16x16x32_bf16 v[68:71], v[140:143], v[164:167], v[68:71]
    v_cvt_pk_bf16_f32 v104, v32, v33
    v_cvt_pk_bf16_f32 v105, v34, v35
    v_mfma_f32_16x16x32_bf16 v[72:75], v[140:143], v[168:171], v[72:75]
    v_cvt_pk_bf16_f32 v106, v44, v45
    v_cvt_pk_bf16_f32 v107, v46, v47
    v_mfma_f32_16x16x32_bf16 v[76:79], v[140:143], v[172:175], v[76:79]
    v_cvt_pk_bf16_f32 v108, v36, v37
    v_cvt_pk_bf16_f32 v109, v38, v39
    v_mfma_f32_16x16x32_bf16 v[80:83], v[144:147], v[164:167], v[80:83]
    v_cvt_pk_bf16_f32 v110, v48, v49
    v_cvt_pk_bf16_f32 v111, v50, v51
    v_mfma_f32_16x16x32_bf16 v[84:87], v[144:147], v[168:171], v[84:87]
    v_permlane16_swap_b32 v104, v106
    v_permlane16_swap_b32 v105, v107
    v_mfma_f32_16x16x32_bf16 v[88:91], v[144:147], v[172:175], v[88:91]
    v_cvt_pk_bf16_f32 v112, v40, v41
    v_cvt_pk_bf16_f32 v113, v42, v43
    v_mfma_f32_16x16x32_bf16 v[92:95], v[148:151], v[164:167], v[92:95]
    v_cvt_pk_bf16_f32 v114, v52, v53
    v_cvt_pk_bf16_f32 v115, v54, v55
    v_mfma_f32_16x16x32_bf16 v[96:99], v[148:151], v[168:171], v[96:99]
    v_permlane16_swap_b32 v108, v110
    v_permlane16_swap_b32 v109, v111
    v_mfma_f32_16x16x32_bf16 v[100:103], v[148:151], v[172:175], v[100:103]
    v_permlane16_swap_b32 v112, v114
    v_permlane16_swap_b32 v113, v115
    v_cvt_pk_bf16_f32 v116, v56, v57
    v_cvt_pk_bf16_f32 v117, v58, v59
    v_cvt_pk_bf16_f32 v118, v68, v69
    v_cvt_pk_bf16_f32 v119, v70, v71
    v_cvt_pk_bf16_f32 v120, v60, v61
    v_cvt_pk_bf16_f32 v121, v62, v63
    v_cvt_pk_bf16_f32 v122, v72, v73
    v_cvt_pk_bf16_f32 v123, v74, v75
    v_permlane16_swap_b32 v116, v118
    v_permlane16_swap_b32 v117, v119
    v_cvt_pk_bf16_f32 v124, v64, v65
    v_cvt_pk_bf16_f32 v125, v66, v67
    v_cvt_pk_bf16_f32 v126, v76, v77
    v_cvt_pk_bf16_f32 v127, v78, v79
    v_permlane16_swap_b32 v120, v122
    v_permlane16_swap_b32 v121, v123
    v_permlane16_swap_b32 v124, v126
    v_permlane16_swap_b32 v125, v127
    v_cvt_pk_bf16_f32 v152, v80, v81
    v_cvt_pk_bf16_f32 v153, v82, v83
    v_cvt_pk_bf16_f32 v154, v92, v93
    v_cvt_pk_bf16_f32 v155, v94, v95
    v_cvt_pk_bf16_f32 v156, v84, v85
    v_cvt_pk_bf16_f32 v157, v86, v87
    v_cvt_pk_bf16_f32 v158, v96, v97
    v_cvt_pk_bf16_f32 v159, v98, v99
    v_permlane16_swap_b32 v152, v154
    v_permlane16_swap_b32 v153, v155
    v_cvt_pk_bf16_f32 v160, v88, v89
    v_cvt_pk_bf16_f32 v161, v90, v91
    v_cvt_pk_bf16_f32 v162, v100, v101
    v_cvt_pk_bf16_f32 v163, v102, v103
    v_permlane16_swap_b32 v156, v158
    v_permlane16_swap_b32 v157, v159
    v_permlane16_swap_b32 v160, v162
    v_permlane16_swap_b32 v161, v163
    v_mov_b64 v[32:33], 0
    v_mov_b64 v[34:35], 0
    v_mov_b64 v[36:37], 0
    v_mov_b64 v[38:39], 0
    v_mov_b64 v[40:41], 0
    v_mov_b64 v[42:43], 0
    v_mov_b64 v[44:45], 0
    v_mov_b64 v[46:47], 0
    v_mov_b64 v[48:49], 0
    v_mov_b64 v[50:51], 0
    v_mov_b64 v[52:53], 0
    v_mov_b64 v[54:55], 0
    v_mov_b64 v[56:57], 0
    v_mov_b64 v[58:59], 0
    v_mov_b64 v[60:61], 0
    v_mov_b64 v[62:63], 0
    v_mov_b64 v[64:65], 0
    v_mov_b64 v[66:67], 0
    v_mov_b64 v[68:69], 0
    v_mov_b64 v[70:71], 0
    v_mov_b64 v[72:73], 0
    v_mov_b64 v[74:75], 0
    v_mov_b64 v[76:77], 0
    v_mov_b64 v[78:79], 0
    v_mov_b64 v[80:81], 0
    v_mov_b64 v[82:83], 0
    v_mov_b64 v[84:85], 0
    v_mov_b64 v[86:87], 0
    v_mov_b64 v[88:89], 0
    v_mov_b64 v[90:91], 0
    s_barrier
    ds_read_b128 v[176:179], v24 offset:0
    ds_read_b128 v[180:183], v25 offset:0
    ds_read_b128 v[184:187], v26 offset:0
    ds_read_b128 v[188:191], v24 offset:6144
    ds_read_b128 v[192:195], v25 offset:6144
    ds_read_b128 v[196:199], v26 offset:6144
    ds_read_b128 v[200:203], v24 offset:12288
    ds_read_b128 v[204:207], v25 offset:12288
    ds_read_b128 v[208:211], v26 offset:12288
    s_cmp_eq_u32 s25, 0
    s_cbranch_scc0 KA_ATT1
    s_waitcnt lgkmcnt(6)
    v_mfma_f32_16x16x32_bf16 v[220:223], v[176:179], v[112:115], 0
    v_mfma_f32_16x16x32_bf16 v[220:223], v[180:183], v[124:127], v[220:223]
    v_mfma_f32_16x16x32_bf16 v[220:223], v[184:187], v[160:163], v[220:223]
    s_waitcnt lgkmcnt(3)
    v_mfma_f32_16x16x32_bf16 v[232:235], v[188:191], v[112:115], 0
    v_mfma_f32_16x16x32_bf16 v[232:235], v[192:195], v[124:127], v[232:235]
    v_mfma_f32_16x16x32_bf16 v[232:235], v[196:199], v[160:163], v[232:235]
    s_waitcnt lgkmcnt(0)
    v_mfma_f32_16x16x32_bf16 v[244:247], v[200:203], v[112:115], 0
    v_mfma_f32_16x16x32_bf16 v[244:247], v[204:207], v[124:127], v[244:247]
    v_mfma_f32_16x16x32_bf16 v[244:247], v[208:211], v[160:163], v[244:247]
    v_mfma_f32_16x16x32_bf16 v[212:215], v[176:179], v[104:107], 0
    v_mfma_f32_16x16x32_bf16 v[212:215], v[180:183], v[116:119], v[212:215]
    ds_write_b128 v26, v[220:223] offset:0
    v_mfma_f32_16x16x32_bf16 v[212:215], v[184:187], v[152:155], v[212:215]
    v_mfma_f32_16x16x32_bf16 v[224:227], v[188:191], v[104:107], 0
    v_mfma_f32_16x16x32_bf16 v[224:227], v[192:195], v[116:119], v[224:227]
    ds_write_b128 v26, v[232:235] offset:6144
    v_mfma_f32_16x16x32_bf16 v[224:227], v[196:199], v[152:155], v[224:227]
    v_mfma_f32_16x16x32_bf16 v[236:239], v[200:203], v[104:107], 0
    v_mfma_f32_16x16x32_bf16 v[236:239], v[204:207], v[116:119], v[236:239]
    ds_write_b128 v26, v[244:247] offset:12288
    v_mfma_f32_16x16x32_bf16 v[236:239], v[208:211], v[152:155], v[236:239]
    v_mfma_f32_16x16x32_bf16 v[216:219], v[176:179], v[108:111], 0
    v_mfma_f32_16x16x32_bf16 v[216:219], v[180:183], v[120:123], v[216:219]
    v_mfma_f32_16x16x32_bf16 v[216:219], v[184:187], v[156:159], v[216:219]
    v_mfma_f32_16x16x32_bf16 v[228:231], v[188:191], v[108:111], 0
    v_mfma_f32_16x16x32_bf16 v[228:231], v[192:195], v[120:123], v[228:231]
    v_mfma_f32_16x16x32_bf16 v[228:231], v[196:199], v[156:159], v[228:231]
    v_mfma_f32_16x16x32_bf16 v[240:243], v[200:203], v[108:111], 0
    v_mfma_f32_16x16x32_bf16 v[240:243], v[204:207], v[120:123], v[240:243]
    v_mfma_f32_16x16x32_bf16 v[240:243], v[208:211], v[156:159], v[240:243]
    s_waitcnt lgkmcnt(0)
    s_barrier
    ds_read_b128 v[128:131], v20 offset:0
    ds_read_b128 v[132:135], v20 offset:6144
    ds_read_b128 v[136:139], v20 offset:12288
    ds_read_b128 v[140:143], v21 offset:0
    ds_read_b128 v[144:147], v21 offset:6144
    ds_read_b128 v[148:151], v21 offset:12288
    s_waitcnt lgkmcnt(3)
    v_pk_add_f32 v[92:93], v[212:213], v[128:129]
    v_pk_add_f32 v[94:95], v[214:215], v[130:131]
    v_pk_add_f32 v[96:97], v[224:225], v[132:133]
    v_pk_add_f32 v[98:99], v[226:227], v[134:135]
    v_pk_add_f32 v[100:101], v[236:237], v[136:137]
    v_pk_add_f32 v[102:103], v[238:239], v[138:139]
    s_waitcnt lgkmcnt(0)
    v_pk_add_f32 v[104:105], v[216:217], v[140:141]
    v_pk_add_f32 v[106:107], v[218:219], v[142:143]
    v_pk_add_f32 v[108:109], v[228:229], v[144:145]
    v_pk_add_f32 v[110:111], v[230:231], v[146:147]
    v_pk_add_f32 v[112:113], v[240:241], v[148:149]
    v_pk_add_f32 v[114:115], v[242:243], v[150:151]
    s_barrier
    ds_read_b128 v[152:155], v250 offset:0
    ds_read_b64_tr_b16 v[224:225], v248 offset:0
    ds_read_b64_tr_b16 v[226:227], v248 offset:1280
    ds_read_b128 v[156:159], v250 offset:2048
    ds_read_b128 v[160:163], v250 offset:4096
    ds_read_b64_tr_b16 v[228:229], v249 offset:0
    ds_read_b64_tr_b16 v[230:231], v249 offset:1280
    ds_read_b64_tr_b16 v[232:233], v248 offset:64
    ds_read_b64_tr_b16 v[234:235], v248 offset:1344
    ds_read_b64_tr_b16 v[236:237], v249 offset:64
    ds_read_b64_tr_b16 v[238:239], v249 offset:1344
    ds_read_b64_tr_b16 v[240:241], v248 offset:128
    ds_read_b64_tr_b16 v[242:243], v248 offset:1408
    v_max3_f32 v116, v92, v93, v94
    v_max3_f32 v117, v95, v96, v97
    v_max3_f32 v116, v116, v98, v99
    v_max3_f32 v117, v117, v100, v101
    v_max3_f32 v116, v116, v102, v103
    v_max_f32 v116, v116, v117
    v_max3_f32 v118, v104, v105, v106
    v_max3_f32 v119, v107, v108, v109
    v_max3_f32 v118, v118, v110, v111
    v_max3_f32 v119, v119, v112, v113
    v_max3_f32 v118, v118, v114, v115
    v_max_f32 v118, v118, v119
    v_mov_b32 v120, v116
    v_mov_b32 v121, v118
    s_nop 0
    v_permlane16_swap_b32 v116, v120
    v_permlane16_swap_b32 v118, v121
    v_max_f32 v116, v116, v120
    v_max_f32 v118, v118, v121
    v_mov_b32 v120, v116
    v_mov_b32 v121, v118
    s_nop 0
    v_permlane32_swap_b32 v116, v120
    v_permlane32_swap_b32 v118, v121
    v_max_f32 v116, v116, v120
    v_max_f32 v118, v118, v121
    v_mul_f32 v116, s42, v116
    v_mul_f32 v118, s42, v118
    v_pk_fma_f32 v[92:93], v[92:93], s[42:43], v[116:117] op_sel_hi:[1,1,0] neg_lo:[0,0,1] neg_hi:[0,0,1]
    v_pk_fma_f32 v[94:95], v[94:95], s[42:43], v[116:117] op_sel_hi:[1,1,0] neg_lo:[0,0,1] neg_hi:[0,0,1]
    v_pk_fma_f32 v[96:97], v[96:97], s[42:43], v[116:117] op_sel_hi:[1,1,0] neg_lo:[0,0,1] neg_hi:[0,0,1]
    v_pk_fma_f32 v[98:99], v[98:99], s[42:43], v[116:117] op_sel_hi:[1,1,0] neg_lo:[0,0,1] neg_hi:[0,0,1]
    v_pk_fma_f32 v[100:101], v[100:101], s[42:43], v[116:117] op_sel_hi:[1,1,0] neg_lo:[0,0,1] neg_hi:[0,0,1]
    v_pk_fma_f32 v[102:103], v[102:103], s[42:43], v[116:117] op_sel_hi:[1,1,0] neg_lo:[0,0,1] neg_hi:[0,0,1]
    v_exp_f32 v92, v92
    v_exp_f32 v93, v93
    v_exp_f32 v94, v94
    v_exp_f32 v95, v95
    v_exp_f32 v96, v96
    v_exp_f32 v97, v97
    v_exp_f32 v98, v98
    v_exp_f32 v99, v99
    v_exp_f32 v100, v100
    v_exp_f32 v101, v101
    v_exp_f32 v102, v102
    v_exp_f32 v103, v103
    v_pk_fma_f32 v[104:105], v[104:105], s[42:43], v[118:119] op_sel_hi:[1,1,0] neg_lo:[0,0,1] neg_hi:[0,0,1]
    v_pk_fma_f32 v[106:107], v[106:107], s[42:43], v[118:119] op_sel_hi:[1,1,0] neg_lo:[0,0,1] neg_hi:[0,0,1]
    v_pk_fma_f32 v[108:109], v[108:109], s[42:43], v[118:119] op_sel_hi:[1,1,0] neg_lo:[0,0,1] neg_hi:[0,0,1]
    v_pk_fma_f32 v[110:111], v[110:111], s[42:43], v[118:119] op_sel_hi:[1,1,0] neg_lo:[0,0,1] neg_hi:[0,0,1]
    v_pk_fma_f32 v[112:113], v[112:113], s[42:43], v[118:119] op_sel_hi:[1,1,0] neg_lo:[0,0,1] neg_hi:[0,0,1]
    v_pk_fma_f32 v[114:115], v[114:115], s[42:43], v[118:119] op_sel_hi:[1,1,0] neg_lo:[0,0,1] neg_hi:[0,0,1]
    v_exp_f32 v104, v104
    v_exp_f32 v105, v105
    v_exp_f32 v106, v106
    v_exp_f32 v107, v107
    v_exp_f32 v108, v108
    v_exp_f32 v109, v109
    v_exp_f32 v110, v110
    v_exp_f32 v111, v111
    v_exp_f32 v112, v112
    v_exp_f32 v113, v113
    v_exp_f32 v114, v114
    v_exp_f32 v115, v115
    v_pk_add_f32 v[116:117], v[92:93], v[94:95]
    v_pk_add_f32 v[116:117], v[116:117], v[96:97]
    v_pk_add_f32 v[116:117], v[116:117], v[98:99]
    v_pk_add_f32 v[116:117], v[116:117], v[100:101]
    v_pk_add_f32 v[116:117], v[116:117], v[102:103]
    v_add_f32 v116, v116, v117
    v_pk_add_f32 v[118:119], v[104:105], v[106:107]
    v_pk_add_f32 v[118:119], v[118:119], v[108:109]
    v_pk_add_f32 v[118:119], v[118:119], v[110:111]
    v_pk_add_f32 v[118:119], v[118:119], v[112:113]
    v_pk_add_f32 v[118:119], v[118:119], v[114:115]
    v_add_f32 v118, v118, v119
    v_mov_b32 v120, v116
    v_mov_b32 v121, v118
    s_nop 0
    v_permlane16_swap_b32 v116, v120
    v_permlane16_swap_b32 v118, v121
    v_add_f32 v116, v116, v120
    v_add_f32 v118, v118, v121
    v_mov_b32 v120, v116
    v_mov_b32 v121, v118
    s_nop 0
    v_permlane32_swap_b32 v116, v120
    v_permlane32_swap_b32 v118, v121
    v_add_f32 v116, v116, v120
    v_add_f32 v118, v118, v121
    v_rcp_f32 v116, v116
    v_rcp_f32 v118, v118
    v_pk_mul_f32 v[92:93], v[92:93], v[116:117] op_sel_hi:[1,0]
    v_pk_mul_f32 v[94:95], v[94:95], v[116:117] op_sel_hi:[1,0]
    v_pk_mul_f32 v[96:97], v[96:97], v[116:117] op_sel_hi:[1,0]
    v_pk_mul_f32 v[98:99], v[98:99], v[116:117] op_sel_hi:[1,0]
    v_pk_mul_f32 v[100:101], v[100:101], v[116:117] op_sel_hi:[1,0]
    v_pk_mul_f32 v[102:103], v[102:103], v[116:117] op_sel_hi:[1,0]
    v_cvt_pk_bf16_f32 v176, v92, v93
    v_cvt_pk_bf16_f32 v177, v94, v95
    v_cvt_pk_bf16_f32 v178, v96, v97
    v_cvt_pk_bf16_f32 v179, v98, v99
    v_cvt_pk_bf16_f32 v180, v100, v101
    v_cvt_pk_bf16_f32 v181, v102, v103
    buffer_store_dwordx4 v[176:179], v252, s[28:31], s48 offen offset:0 sc1
    buffer_store_dwordx2 v[180:181], v253, s[28:31], s50 offen offset:0 sc1
    ds_write_b128 v4, v[176:179] offset:0
    ds_write_b64 v5, v[180:181] offset:0
    v_pk_mul_f32 v[104:105], v[104:105], v[118:119] op_sel_hi:[1,0]
    v_pk_mul_f32 v[106:107], v[106:107], v[118:119] op_sel_hi:[1,0]
    v_pk_mul_f32 v[108:109], v[108:109], v[118:119] op_sel_hi:[1,0]
    v_pk_mul_f32 v[110:111], v[110:111], v[118:119] op_sel_hi:[1,0]
    v_pk_mul_f32 v[112:113], v[112:113], v[118:119] op_sel_hi:[1,0]
    v_pk_mul_f32 v[114:115], v[114:115], v[118:119] op_sel_hi:[1,0]
    v_cvt_pk_bf16_f32 v182, v104, v105
    v_cvt_pk_bf16_f32 v183, v106, v107
    v_cvt_pk_bf16_f32 v184, v108, v109
    v_cvt_pk_bf16_f32 v185, v110, v111
    v_cvt_pk_bf16_f32 v186, v112, v113
    v_cvt_pk_bf16_f32 v187, v114, v115
    buffer_store_dwordx4 v[182:185], v252, s[28:31], s48 offen offset:1024 sc1
    buffer_store_dwordx2 v[186:187], v253, s[28:31], s50 offen offset:512 sc1
    ds_write_b128 v4, v[182:185] offset:1024
    ds_write_b64 v5, v[186:187] offset:512
    s_waitcnt lgkmcnt(4)
    s_branch KA_ATTD
KA_ATT1:
    s_waitcnt lgkmcnt(6)
    v_mfma_f32_16x16x32_bf16 v[212:215], v[176:179], v[104:107], 0
    v_mfma_f32_16x16x32_bf16 v[212:215], v[180:183], v[116:119], v[212:215]
    v_mfma_f32_16x16x32_bf16 v[212:215], v[184:187], v[152:155], v[212:215]
    s_waitcnt lgkmcnt(3)
    v_mfma_f32_16x16x32_bf16 v[224:227], v[188:191], v[104:107], 0
    v_mfma_f32_16x16x32_bf16 v[224:227], v[192:195], v[116:119], v[224:227]
    v_mfma_f32_16x16x32_bf16 v[224:227], v[196:199], v[152:155], v[224:227]
    s_waitcnt lgkmcnt(0)
    v_mfma_f32_16x16x32_bf16 v[236:239], v[200:203], v[104:107], 0
    v_mfma_f32_16x16x32_bf16 v[236:239], v[204:207], v[116:119], v[236:239]
    v_mfma_f32_16x16x32_bf16 v[236:239], v[208:211], v[152:155], v[236:239]
    v_mfma_f32_16x16x32_bf16 v[216:219], v[176:179], v[108:111], 0
    v_mfma_f32_16x16x32_bf16 v[216:219], v[180:183], v[120:123], v[216:219]
    ds_write_b128 v24, v[212:215] offset:0
    v_mfma_f32_16x16x32_bf16 v[216:219], v[184:187], v[156:159], v[216:219]
    v_mfma_f32_16x16x32_bf16 v[228:231], v[188:191], v[108:111], 0
    v_mfma_f32_16x16x32_bf16 v[228:231], v[192:195], v[120:123], v[228:231]
    ds_write_b128 v24, v[224:227] offset:6144
    v_mfma_f32_16x16x32_bf16 v[228:231], v[196:199], v[156:159], v[228:231]
    v_mfma_f32_16x16x32_bf16 v[240:243], v[200:203], v[108:111], 0
    v_mfma_f32_16x16x32_bf16 v[240:243], v[204:207], v[120:123], v[240:243]
    ds_write_b128 v24, v[236:239] offset:12288
    v_mfma_f32_16x16x32_bf16 v[240:243], v[208:211], v[156:159], v[240:243]
    v_mfma_f32_16x16x32_bf16 v[220:223], v[176:179], v[112:115], 0
    v_mfma_f32_16x16x32_bf16 v[220:223], v[180:183], v[124:127], v[220:223]
    ds_write_b128 v25, v[216:219] offset:0
    v_mfma_f32_16x16x32_bf16 v[220:223], v[184:187], v[160:163], v[220:223]
    v_mfma_f32_16x16x32_bf16 v[232:235], v[188:191], v[112:115], 0
    v_mfma_f32_16x16x32_bf16 v[232:235], v[192:195], v[124:127], v[232:235]
    ds_write_b128 v25, v[228:231] offset:6144
    v_mfma_f32_16x16x32_bf16 v[232:235], v[196:199], v[160:163], v[232:235]
    v_mfma_f32_16x16x32_bf16 v[244:247], v[200:203], v[112:115], 0
    v_mfma_f32_16x16x32_bf16 v[244:247], v[204:207], v[124:127], v[244:247]
    ds_write_b128 v25, v[240:243] offset:12288
    v_mfma_f32_16x16x32_bf16 v[244:247], v[208:211], v[160:163], v[244:247]
    s_waitcnt lgkmcnt(0)
    s_barrier
    ds_read_b128 v[128:131], v22 offset:0
    ds_read_b128 v[132:135], v22 offset:6144
    ds_read_b128 v[136:139], v22 offset:12288
    s_waitcnt lgkmcnt(0)
    v_pk_add_f32 v[92:93], v[220:221], v[128:129]
    v_pk_add_f32 v[94:95], v[222:223], v[130:131]
    v_pk_add_f32 v[96:97], v[232:233], v[132:133]
    v_pk_add_f32 v[98:99], v[234:235], v[134:135]
    v_pk_add_f32 v[100:101], v[244:245], v[136:137]
    v_pk_add_f32 v[102:103], v[246:247], v[138:139]
    s_barrier
    ds_read_b128 v[152:155], v250 offset:0
    ds_read_b64_tr_b16 v[224:225], v248 offset:0
    ds_read_b64_tr_b16 v[226:227], v248 offset:1280
    ds_read_b128 v[156:159], v250 offset:2048
    ds_read_b128 v[160:163], v250 offset:4096
    ds_read_b64_tr_b16 v[228:229], v249 offset:0
    ds_read_b64_tr_b16 v[230:231], v249 offset:1280
    ds_read_b64_tr_b16 v[232:233], v248 offset:64
    ds_read_b64_tr_b16 v[234:235], v248 offset:1344
    ds_read_b64_tr_b16 v[236:237], v249 offset:64
    ds_read_b64_tr_b16 v[238:239], v249 offset:1344
    ds_read_b64_tr_b16 v[240:241], v248 offset:128
    ds_read_b64_tr_b16 v[242:243], v248 offset:1408
    v_max3_f32 v116, v92, v93, v94
    v_max3_f32 v117, v95, v96, v97
    v_max3_f32 v116, v116, v98, v99
    v_max3_f32 v117, v117, v100, v101
    v_max3_f32 v116, v116, v102, v103
    v_max_f32 v116, v116, v117
    v_mov_b32 v120, v116
    s_nop 1
    v_permlane16_swap_b32 v116, v120
    v_max_f32 v116, v116, v120
    v_mov_b32 v120, v116
    s_nop 1
    v_permlane32_swap_b32 v116, v120
    v_max_f32 v116, v116, v120
    v_mul_f32 v116, s42, v116
    v_pk_fma_f32 v[92:93], v[92:93], s[42:43], v[116:117] op_sel_hi:[1,1,0] neg_lo:[0,0,1] neg_hi:[0,0,1]
    v_pk_fma_f32 v[94:95], v[94:95], s[42:43], v[116:117] op_sel_hi:[1,1,0] neg_lo:[0,0,1] neg_hi:[0,0,1]
    v_pk_fma_f32 v[96:97], v[96:97], s[42:43], v[116:117] op_sel_hi:[1,1,0] neg_lo:[0,0,1] neg_hi:[0,0,1]
    v_pk_fma_f32 v[98:99], v[98:99], s[42:43], v[116:117] op_sel_hi:[1,1,0] neg_lo:[0,0,1] neg_hi:[0,0,1]
    v_pk_fma_f32 v[100:101], v[100:101], s[42:43], v[116:117] op_sel_hi:[1,1,0] neg_lo:[0,0,1] neg_hi:[0,0,1]
    v_pk_fma_f32 v[102:103], v[102:103], s[42:43], v[116:117] op_sel_hi:[1,1,0] neg_lo:[0,0,1] neg_hi:[0,0,1]
    v_exp_f32 v92, v92
    v_exp_f32 v93, v93
    v_exp_f32 v94, v94
    v_exp_f32 v95, v95
    v_exp_f32 v96, v96
    v_exp_f32 v97, v97
    v_exp_f32 v98, v98
    v_exp_f32 v99, v99
    v_exp_f32 v100, v100
    v_exp_f32 v101, v101
    v_exp_f32 v102, v102
    v_exp_f32 v103, v103
    v_pk_add_f32 v[116:117], v[92:93], v[94:95]
    v_pk_add_f32 v[116:117], v[116:117], v[96:97]
    v_pk_add_f32 v[116:117], v[116:117], v[98:99]
    v_pk_add_f32 v[116:117], v[116:117], v[100:101]
    v_pk_add_f32 v[116:117], v[116:117], v[102:103]
    v_add_f32 v116, v116, v117
    v_mov_b32 v120, v116
    s_nop 1
    v_permlane16_swap_b32 v116, v120
    v_add_f32 v116, v116, v120
    v_mov_b32 v120, v116
    s_nop 1
    v_permlane32_swap_b32 v116, v120
    v_add_f32 v116, v116, v120
    v_rcp_f32 v116, v116
    s_nop 0
    v_pk_mul_f32 v[92:93], v[92:93], v[116:117] op_sel_hi:[1,0]
    v_pk_mul_f32 v[94:95], v[94:95], v[116:117] op_sel_hi:[1,0]
    v_pk_mul_f32 v[96:97], v[96:97], v[116:117] op_sel_hi:[1,0]
    v_pk_mul_f32 v[98:99], v[98:99], v[116:117] op_sel_hi:[1,0]
    v_pk_mul_f32 v[100:101], v[100:101], v[116:117] op_sel_hi:[1,0]
    v_pk_mul_f32 v[102:103], v[102:103], v[116:117] op_sel_hi:[1,0]
    v_cvt_pk_bf16_f32 v188, v92, v93
    v_cvt_pk_bf16_f32 v189, v94, v95
    v_cvt_pk_bf16_f32 v190, v96, v97
    v_cvt_pk_bf16_f32 v191, v98, v99
    v_cvt_pk_bf16_f32 v192, v100, v101
    v_cvt_pk_bf16_f32 v193, v102, v103
    buffer_store_dwordx4 v[188:191], v252, s[28:31], s48 offen offset:2048 sc1
    buffer_store_dwordx2 v[192:193], v253, s[28:31], s50 offen offset:1024 sc1
    ds_write_b128 v4, v[188:191] offset:2048
    ds_write_b64 v5, v[192:193] offset:1024
    s_waitcnt lgkmcnt(2)
KA_ATTD:
    v_mfma_f32_16x16x32_bf16 v[92:95], v[152:155], v[224:227], 0
    ds_read_b128 v[164:167], v251 offset:0
    v_mfma_f32_16x16x32_bf16 v[96:99], v[156:159], v[224:227], 0
    ds_read_b64_tr_b16 v[12:13], v248 offset:10240
    v_mfma_f32_16x16x32_bf16 v[100:103], v[160:163], v[224:227], 0
    ds_read_b64_tr_b16 v[14:15], v248 offset:11520
    v_mfma_f32_16x16x32_bf16 v[104:107], v[152:155], v[228:231], 0
    ds_read_b128 v[168:171], v251 offset:2048
    s_add_u32 s40, s40, 1
    v_mfma_f32_16x16x32_bf16 v[108:111], v[156:159], v[228:231], 0
    ds_read_b128 v[172:175], v251 offset:4096
    s_and_b32 s39, s40, 3
    v_mfma_f32_16x16x32_bf16 v[112:115], v[160:163], v[228:231], 0
    ds_read_b64_tr_b16 v[16:17], v249 offset:10240
    s_cmp_eq_u32 s39, 0
    v_mfma_f32_16x16x32_bf16 v[116:119], v[152:155], v[232:235], 0
    ds_read_b64_tr_b16 v[18:19], v249 offset:11520
    s_cselect_b32 s39, 4294856704, s41
    v_mfma_f32_16x16x32_bf16 v[120:123], v[156:159], v[232:235], 0
    ds_read_b64_tr_b16 v[20:21], v248 offset:10304
    v_mfma_f32_16x16x32_bf16 v[124:127], v[160:163], v[232:235], 0
    ds_read_b64_tr_b16 v[22:23], v248 offset:11584
    v_mfma_f32_16x16x32_bf16 v[128:131], v[152:155], v[236:239], 0
    ds_read_b64_tr_b16 v[24:25], v249 offset:10304
    v_mfma_f32_16x16x32_bf16 v[132:135], v[156:159], v[236:239], 0
    ds_read_b64_tr_b16 v[26:27], v249 offset:11584
    v_mfma_f32_16x16x32_bf16 v[136:139], v[160:163], v[236:239], 0
    ds_read_b64_tr_b16 v[28:29], v248 offset:10368
    v_mfma_f32_16x16x32_bf16 v[140:143], v[152:155], v[240:243], 0
    ds_read_b64_tr_b16 v[30:31], v248 offset:11648
    v_mfma_f32_16x16x32_bf16 v[144:147], v[156:159], v[240:243], 0
    v_add_u32 v250, s39, v250
    v_add_u32 v251, s39, v251
    v_mfma_f32_16x16x32_bf16 v[148:151], v[160:163], v[240:243], 0
    v_add_u32 v248, s39, v248
    v_add_u32 v249, s39, v249
    s_waitcnt lgkmcnt(8)
    v_mfma_f32_16x16x32_bf16 v[92:95], v[164:167], v[12:15], v[92:95]
    v_mfma_f32_16x16x32_bf16 v[96:99], v[168:171], v[12:15], v[96:99]
    s_waitcnt lgkmcnt(0)
    s_barrier
    v_mfma_f32_16x16x32_bf16 v[100:103], v[172:175], v[12:15], v[100:103]
    ds_read_b128 v[152:155], v250 offset:0
    v_mfma_f32_16x16x32_bf16 v[104:107], v[164:167], v[16:19], v[104:107]
    ds_read_b64_tr_b16 v[224:225], v248 offset:0
    v_mfma_f32_16x16x32_bf16 v[108:111], v[168:171], v[16:19], v[108:111]
    ds_read_b64_tr_b16 v[226:227], v248 offset:1280
    v_mfma_f32_16x16x32_bf16 v[112:115], v[172:175], v[16:19], v[112:115]
    ds_read_b128 v[156:159], v250 offset:2048
    v_mfma_f32_16x16x32_bf16 v[116:119], v[164:167], v[20:23], v[116:119]
    ds_read_b128 v[160:163], v250 offset:4096
    v_mfma_f32_16x16x32_bf16 v[120:123], v[168:171], v[20:23], v[120:123]
    ds_read_b64_tr_b16 v[228:229], v249 offset:0
    v_mfma_f32_16x16x32_bf16 v[124:127], v[172:175], v[20:23], v[124:127]
    ds_read_b64_tr_b16 v[230:231], v249 offset:1280
    v_mfma_f32_16x16x32_bf16 v[128:131], v[164:167], v[24:27], v[128:131]
    ds_read_b64_tr_b16 v[232:233], v248 offset:64
    v_mfma_f32_16x16x32_bf16 v[132:135], v[168:171], v[24:27], v[132:135]
    ds_read_b64_tr_b16 v[234:235], v248 offset:1344
    v_mfma_f32_16x16x32_bf16 v[136:139], v[172:175], v[24:27], v[136:139]
    ds_read_b64_tr_b16 v[236:237], v249 offset:64
    v_mfma_f32_16x16x32_bf16 v[140:143], v[164:167], v[28:31], v[140:143]
    ds_read_b64_tr_b16 v[238:239], v249 offset:1344
    v_mfma_f32_16x16x32_bf16 v[144:147], v[168:171], v[28:31], v[144:147]
    ds_read_b64_tr_b16 v[240:241], v248 offset:128
    v_mfma_f32_16x16x32_bf16 v[148:151], v[172:175], v[28:31], v[148:151]
    ds_read_b64_tr_b16 v[242:243], v248 offset:1408
    s_waitcnt lgkmcnt(6)
    v_mfma_f32_16x16x32_bf16 v[92:95], v[152:155], v[224:227], v[92:95]
    ds_read_b128 v[164:167], v251 offset:0
    v_mfma_f32_16x16x32_bf16 v[96:99], v[156:159], v[224:227], v[96:99]
    ds_read_b64_tr_b16 v[12:13], v248 offset:10240
    v_mfma_f32_16x16x32_bf16 v[100:103], v[160:163], v[224:227], v[100:103]
    ds_read_b64_tr_b16 v[14:15], v248 offset:11520
    v_mfma_f32_16x16x32_bf16 v[104:107], v[152:155], v[228:231], v[104:107]
    ds_read_b128 v[168:171], v251 offset:2048
    s_add_u32 s40, s40, 1
    v_mfma_f32_16x16x32_bf16 v[108:111], v[156:159], v[228:231], v[108:111]
    ds_read_b128 v[172:175], v251 offset:4096
    s_and_b32 s39, s40, 3
    v_mfma_f32_16x16x32_bf16 v[112:115], v[160:163], v[228:231], v[112:115]
    ds_read_b64_tr_b16 v[16:17], v249 offset:10240
    s_cmp_eq_u32 s39, 0
    s_waitcnt lgkmcnt(10)
    v_mfma_f32_16x16x32_bf16 v[116:119], v[152:155], v[232:235], v[116:119]
    ds_read_b64_tr_b16 v[18:19], v249 offset:11520
    s_cselect_b32 s39, 4294856704, s41
    v_mfma_f32_16x16x32_bf16 v[120:123], v[156:159], v[232:235], v[120:123]
    ds_read_b64_tr_b16 v[20:21], v248 offset:10304
    v_mfma_f32_16x16x32_bf16 v[124:127], v[160:163], v[232:235], v[124:127]
    ds_read_b64_tr_b16 v[22:23], v248 offset:11584
    s_waitcnt lgkmcnt(9)
    v_mfma_f32_16x16x32_bf16 v[128:131], v[152:155], v[236:239], v[128:131]
    ds_read_b64_tr_b16 v[24:25], v249 offset:10304
    v_mfma_f32_16x16x32_bf16 v[132:135], v[156:159], v[236:239], v[132:135]
    ds_read_b64_tr_b16 v[26:27], v249 offset:11584
    v_mfma_f32_16x16x32_bf16 v[136:139], v[160:163], v[236:239], v[136:139]
    ds_read_b64_tr_b16 v[28:29], v248 offset:10368
    v_mfma_f32_16x16x32_bf16 v[140:143], v[152:155], v[240:243], v[140:143]
    ds_read_b64_tr_b16 v[30:31], v248 offset:11648
    v_mfma_f32_16x16x32_bf16 v[144:147], v[156:159], v[240:243], v[144:147]
    v_add_u32 v250, s39, v250
    v_add_u32 v251, s39, v251
    v_mfma_f32_16x16x32_bf16 v[148:151], v[160:163], v[240:243], v[148:151]
    v_add_u32 v248, s39, v248
    v_add_u32 v249, s39, v249
    s_waitcnt lgkmcnt(8)
    v_mfma_f32_16x16x32_bf16 v[92:95], v[164:167], v[12:15], v[92:95]
    v_mfma_f32_16x16x32_bf16 v[96:99], v[168:171], v[12:15], v[96:99]
    s_waitcnt lgkmcnt(0)
    s_barrier
    v_mfma_f32_16x16x32_bf16 v[100:103], v[172:175], v[12:15], v[100:103]
    ds_read_b128 v[152:155], v250 offset:0
    v_mfma_f32_16x16x32_bf16 v[104:107], v[164:167], v[16:19], v[104:107]
    ds_read_b64_tr_b16 v[224:225], v248 offset:0
    v_mfma_f32_16x16x32_bf16 v[108:111], v[168:171], v[16:19], v[108:111]
    ds_read_b64_tr_b16 v[226:227], v248 offset:1280
    v_mfma_f32_16x16x32_bf16 v[112:115], v[172:175], v[16:19], v[112:115]
    ds_read_b128 v[156:159], v250 offset:2048
    v_mfma_f32_16x16x32_bf16 v[116:119], v[164:167], v[20:23], v[116:119]
    ds_read_b128 v[160:163], v250 offset:4096
    v_mfma_f32_16x16x32_bf16 v[120:123], v[168:171], v[20:23], v[120:123]
    ds_read_b64_tr_b16 v[228:229], v249 offset:0
    v_mfma_f32_16x16x32_bf16 v[124:127], v[172:175], v[20:23], v[124:127]
    ds_read_b64_tr_b16 v[230:231], v249 offset:1280
    v_mfma_f32_16x16x32_bf16 v[128:131], v[164:167], v[24:27], v[128:131]
    ds_read_b64_tr_b16 v[232:233], v248 offset:64
    v_mfma_f32_16x16x32_bf16 v[132:135], v[168:171], v[24:27], v[132:135]
    ds_read_b64_tr_b16 v[234:235], v248 offset:1344
    v_mfma_f32_16x16x32_bf16 v[136:139], v[172:175], v[24:27], v[136:139]
    ds_read_b64_tr_b16 v[236:237], v249 offset:64
    v_mfma_f32_16x16x32_bf16 v[140:143], v[164:167], v[28:31], v[140:143]
    ds_read_b64_tr_b16 v[238:239], v249 offset:1344
    v_mfma_f32_16x16x32_bf16 v[144:147], v[168:171], v[28:31], v[144:147]
    ds_read_b64_tr_b16 v[240:241], v248 offset:128
    v_mfma_f32_16x16x32_bf16 v[148:151], v[172:175], v[28:31], v[148:151]
    ds_read_b64_tr_b16 v[242:243], v248 offset:1408
    s_waitcnt lgkmcnt(6)
    v_mfma_f32_16x16x32_bf16 v[92:95], v[152:155], v[224:227], v[92:95]
    ds_read_b128 v[164:167], v251 offset:0
    s_waitcnt vmcnt(0)
    buffer_store_dword v3, v1, s[4:7], 0 offen sc1
    v_mfma_f32_16x16x32_bf16 v[96:99], v[156:159], v[224:227], v[96:99]
    ds_read_b64_tr_b16 v[12:13], v248 offset:10240
    v_mfma_f32_16x16x32_bf16 v[100:103], v[160:163], v[224:227], v[100:103]
    ds_read_b64_tr_b16 v[14:15], v248 offset:11520
    v_mfma_f32_16x16x32_bf16 v[104:107], v[152:155], v[228:231], v[104:107]
    ds_read_b128 v[168:171], v251 offset:2048
    s_add_u32 s40, s40, 1
    v_mfma_f32_16x16x32_bf16 v[108:111], v[156:159], v[228:231], v[108:111]
    ds_read_b128 v[172:175], v251 offset:4096
    s_and_b32 s39, s40, 3
    v_mfma_f32_16x16x32_bf16 v[112:115], v[160:163], v[228:231], v[112:115]
    ds_read_b64_tr_b16 v[16:17], v249 offset:10240
    s_cmp_eq_u32 s39, 0
    s_waitcnt lgkmcnt(10)
    v_mfma_f32_16x16x32_bf16 v[116:119], v[152:155], v[232:235], v[116:119]
    ds_read_b64_tr_b16 v[18:19], v249 offset:11520
    s_cselect_b32 s39, 4294856704, s41
    v_mfma_f32_16x16x32_bf16 v[120:123], v[156:159], v[232:235], v[120:123]
    ds_read_b64_tr_b16 v[20:21], v248 offset:10304
    v_mfma_f32_16x16x32_bf16 v[124:127], v[160:163], v[232:235], v[124:127]
    ds_read_b64_tr_b16 v[22:23], v248 offset:11584
    s_waitcnt lgkmcnt(9)
    v_mfma_f32_16x16x32_bf16 v[128:131], v[152:155], v[236:239], v[128:131]
    ds_read_b64_tr_b16 v[24:25], v249 offset:10304
    v_mfma_f32_16x16x32_bf16 v[132:135], v[156:159], v[236:239], v[132:135]
    ds_read_b64_tr_b16 v[26:27], v249 offset:11584
    v_mfma_f32_16x16x32_bf16 v[136:139], v[160:163], v[236:239], v[136:139]
    ds_read_b64_tr_b16 v[28:29], v248 offset:10368
    v_mfma_f32_16x16x32_bf16 v[140:143], v[152:155], v[240:243], v[140:143]
    ds_read_b64_tr_b16 v[30:31], v248 offset:11648
    v_mfma_f32_16x16x32_bf16 v[144:147], v[156:159], v[240:243], v[144:147]
    v_add_u32 v250, s39, v250
    v_add_u32 v251, s39, v251
    v_mfma_f32_16x16x32_bf16 v[148:151], v[160:163], v[240:243], v[148:151]
    v_add_u32 v248, s39, v248
    v_add_u32 v249, s39, v249
    s_waitcnt lgkmcnt(8)
    v_mfma_f32_16x16x32_bf16 v[92:95], v[164:167], v[12:15], v[92:95]
    v_mfma_f32_16x16x32_bf16 v[96:99], v[168:171], v[12:15], v[96:99]
    s_waitcnt lgkmcnt(0)
    s_barrier
    v_mfma_f32_16x16x32_bf16 v[100:103], v[172:175], v[12:15], v[100:103]
    ds_read_b128 v[152:155], v250 offset:0
    v_mfma_f32_16x16x32_bf16 v[104:107], v[164:167], v[16:19], v[104:107]
    ds_read_b64_tr_b16 v[224:225], v248 offset:0
    v_mfma_f32_16x16x32_bf16 v[108:111], v[168:171], v[16:19], v[108:111]
    ds_read_b64_tr_b16 v[226:227], v248 offset:1280
    v_mfma_f32_16x16x32_bf16 v[112:115], v[172:175], v[16:19], v[112:115]
    ds_read_b128 v[156:159], v250 offset:2048
    v_mfma_f32_16x16x32_bf16 v[116:119], v[164:167], v[20:23], v[116:119]
    ds_read_b128 v[160:163], v250 offset:4096
    v_cvt_pk_bf16_f32 v194, v92, v93
    v_cvt_pk_bf16_f32 v195, v94, v95
    v_mfma_f32_16x16x32_bf16 v[120:123], v[168:171], v[20:23], v[120:123]
    ds_read_b64_tr_b16 v[228:229], v249 offset:0
    v_cvt_pk_bf16_f32 v196, v96, v97
    v_cvt_pk_bf16_f32 v197, v98, v99
    v_mfma_f32_16x16x32_bf16 v[124:127], v[172:175], v[20:23], v[124:127]
    ds_read_b64_tr_b16 v[230:231], v249 offset:1280
    v_cvt_pk_bf16_f32 v198, v100, v101
    v_cvt_pk_bf16_f32 v199, v102, v103
    v_mfma_f32_16x16x32_bf16 v[128:131], v[164:167], v[24:27], v[128:131]
    ds_read_b64_tr_b16 v[232:233], v248 offset:64
    v_cvt_pk_bf16_f32 v200, v104, v105
    v_cvt_pk_bf16_f32 v201, v106, v107
    v_mfma_f32_16x16x32_bf16 v[132:135], v[168:171], v[24:27], v[132:135]
    ds_read_b64_tr_b16 v[234:235], v248 offset:1344
    v_cvt_pk_bf16_f32 v202, v108, v109
    v_cvt_pk_bf16_f32 v203, v110, v111
    v_mfma_f32_16x16x32_bf16 v[136:139], v[172:175], v[24:27], v[136:139]
    ds_read_b64_tr_b16 v[236:237], v249 offset:64
    v_cvt_pk_bf16_f32 v204, v112, v113
    v_cvt_pk_bf16_f32 v205, v114, v115
    v_mfma_f32_16x16x32_bf16 v[140:143], v[164:167], v[28:31], v[140:143]
    ds_read_b64_tr_b16 v[238:239], v249 offset:1344
    v_cvt_pk_bf16_f32 v206, v116, v117
    v_cvt_pk_bf16_f32 v207, v118, v119
    v_mfma_f32_16x16x32_bf16 v[144:147], v[168:171], v[28:31], v[144:147]
    ds_read_b64_tr_b16 v[240:241], v248 offset:128
    v_cvt_pk_bf16_f32 v208, v120, v121
    v_cvt_pk_bf16_f32 v209, v122, v123
    v_mfma_f32_16x16x32_bf16 v[148:151], v[172:175], v[28:31], v[148:151]
    ds_read_b64_tr_b16 v[242:243], v248 offset:1408
    v_cvt_pk_bf16_f32 v210, v124, v125
    v_cvt_pk_bf16_f32 v211, v126, v127
KA_HLOOP:
    s_waitcnt lgkmcnt(6)
    v_mfma_f32_16x16x32_bf16 v[92:95], v[152:155], v[224:227], 0
    ds_read_b128 v[164:167], v251 offset:0
    v_mfma_f32_16x16x32_bf16 v[96:99], v[156:159], v[224:227], 0
    ds_read_b64_tr_b16 v[12:13], v248 offset:10240
    v_cvt_pk_bf16_f32 v212, v128, v129
    v_cvt_pk_bf16_f32 v213, v130, v131
    v_mfma_f32_16x16x32_bf16 v[100:103], v[160:163], v[224:227], 0
    ds_read_b64_tr_b16 v[14:15], v248 offset:11520
    v_cvt_pk_bf16_f32 v214, v132, v133
    v_cvt_pk_bf16_f32 v215, v134, v135
    v_mfma_f32_16x16x32_bf16 v[104:107], v[152:155], v[228:231], 0
    ds_read_b128 v[168:171], v251 offset:2048
    s_add_u32 s40, s40, 1
    v_cvt_pk_bf16_f32 v216, v136, v137
    v_cvt_pk_bf16_f32 v217, v138, v139
    v_mfma_f32_16x16x32_bf16 v[108:111], v[156:159], v[228:231], 0
    ds_read_b128 v[172:175], v251 offset:4096
    s_and_b32 s39, s40, 3
    v_cvt_pk_bf16_f32 v218, v140, v141
    v_cvt_pk_bf16_f32 v219, v142, v143
    v_mfma_f32_16x16x32_bf16 v[112:115], v[160:163], v[228:231], 0
    ds_read_b64_tr_b16 v[16:17], v249 offset:10240
    s_cmp_eq_u32 s39, 0
    v_cvt_pk_bf16_f32 v220, v144, v145
    v_cvt_pk_bf16_f32 v221, v146, v147
    s_waitcnt lgkmcnt(10)
    v_mfma_f32_16x16x32_bf16 v[116:119], v[152:155], v[232:235], 0
    ds_read_b64_tr_b16 v[18:19], v249 offset:11520
    s_cselect_b32 s39, 4294856704, s41
    v_cvt_pk_bf16_f32 v222, v148, v149
    v_cvt_pk_bf16_f32 v223, v150, v151
    v_mfma_f32_16x16x32_bf16 v[120:123], v[156:159], v[232:235], 0
    ds_read_b64_tr_b16 v[20:21], v248 offset:10304
    v_mfma_f32_16x16x32_bf16 v[124:127], v[160:163], v[232:235], 0
    ds_read_b64_tr_b16 v[22:23], v248 offset:11584
    s_waitcnt lgkmcnt(9)
    v_mfma_f32_16x16x32_bf16 v[128:131], v[152:155], v[236:239], 0
    ds_read_b64_tr_b16 v[24:25], v249 offset:10304
    v_mfma_f32_16x16x32_bf16 v[132:135], v[156:159], v[236:239], 0
    ds_read_b64_tr_b16 v[26:27], v249 offset:11584
    v_mfma_f32_16x16x32_bf16 v[136:139], v[160:163], v[236:239], 0
    ds_read_b64_tr_b16 v[28:29], v248 offset:10368
    v_mfma_f32_16x16x32_bf16 v[140:143], v[152:155], v[240:243], 0
    ds_read_b64_tr_b16 v[30:31], v248 offset:11648
    v_mfma_f32_16x16x32_bf16 v[144:147], v[156:159], v[240:243], 0
    v_add_u32 v250, s39, v250
    v_add_u32 v251, s39, v251
    v_mfma_f32_16x16x32_bf16 v[148:151], v[160:163], v[240:243], 0
    v_add_u32 v248, s39, v248
    v_add_u32 v249, s39, v249
    s_waitcnt lgkmcnt(8)
    v_mfma_f32_16x16x32_bf16 v[92:95], v[164:167], v[12:15], v[92:95]
    v_mfma_f32_16x16x32_bf16 v[96:99], v[168:171], v[12:15], v[96:99]
    s_waitcnt lgkmcnt(0)
    s_barrier
    v_mfma_f32_16x16x32_bf16 v[100:103], v[172:175], v[12:15], v[100:103]
    ds_read_b128 v[176:179], v4 offset:0
    v_mfma_f32_16x16x32_bf16 v[104:107], v[164:167], v[16:19], v[104:107]
    ds_read_b64 v[180:181], v5 offset:0
    v_mfma_f32_16x16x32_bf16 v[108:111], v[168:171], v[16:19], v[108:111]
    ds_read_b128 v[182:185], v4 offset:1024
    v_mfma_f32_16x16x32_bf16 v[112:115], v[172:175], v[16:19], v[112:115]
    ds_read_b64 v[186:187], v5 offset:512
    v_mfma_f32_16x16x32_bf16 v[116:119], v[164:167], v[20:23], v[116:119]
    ds_read_b128 v[188:191], v4 offset:2048
    v_mfma_f32_16x16x32_bf16 v[120:123], v[168:171], v[20:23], v[120:123]
    ds_read_b64 v[192:193], v5 offset:1024
    v_mfma_f32_16x16x32_bf16 v[124:127], v[172:175], v[20:23], v[124:127]
    ds_read_b128 v[152:155], v250 offset:0
    v_mfma_f32_16x16x32_bf16 v[128:131], v[164:167], v[24:27], v[128:131]
    ds_read_b64_tr_b16 v[224:225], v248 offset:0
    v_mfma_f32_16x16x32_bf16 v[132:135], v[168:171], v[24:27], v[132:135]
    ds_read_b64_tr_b16 v[226:227], v248 offset:1280
    v_mfma_f32_16x16x32_bf16 v[136:139], v[172:175], v[24:27], v[136:139]
    ds_read_b128 v[156:159], v250 offset:2048
    v_mfma_f32_16x16x32_bf16 v[140:143], v[164:167], v[28:31], v[140:143]
    ds_read_b128 v[160:163], v250 offset:4096
    v_mfma_f32_16x16x32_bf16 v[144:147], v[168:171], v[28:31], v[144:147]
    ds_read_b64_tr_b16 v[228:229], v249 offset:0
    v_mfma_f32_16x16x32_bf16 v[148:151], v[172:175], v[28:31], v[148:151]
    ds_read_b64_tr_b16 v[230:231], v249 offset:1280
    s_waitcnt lgkmcnt(7)
    v_mfma_f32_16x16x32_bf16 v[32:35], v[194:197], v[176:179], v[32:35]
    ds_read_b64_tr_b16 v[232:233], v248 offset:64
    v_mfma_f32_16x16x32_bf16 v[36:39], v[194:197], v[182:185], v[36:39]
    ds_read_b64_tr_b16 v[234:235], v248 offset:1344
    v_mfma_f32_16x16x32_bf16 v[40:43], v[194:197], v[188:191], v[40:43]
    ds_read_b64_tr_b16 v[236:237], v249 offset:64
    ds_read_b64_tr_b16 v[238:239], v249 offset:1344
    ds_read_b64_tr_b16 v[240:241], v248 offset:128
    ds_read_b64_tr_b16 v[242:243], v248 offset:1408
    s_waitcnt lgkmcnt(6)
    v_mfma_f32_16x16x32_bf16 v[92:95], v[152:155], v[224:227], v[92:95]
    ds_read_b128 v[164:167], v251 offset:0
    v_mfma_f32_16x16x32_bf16 v[96:99], v[156:159], v[224:227], v[96:99]
    ds_read_b64_tr_b16 v[12:13], v248 offset:10240
    v_mfma_f32_16x16x32_bf16 v[100:103], v[160:163], v[224:227], v[100:103]
    ds_read_b64_tr_b16 v[14:15], v248 offset:11520
    v_mfma_f32_16x16x32_bf16 v[104:107], v[152:155], v[228:231], v[104:107]
    ds_read_b128 v[168:171], v251 offset:2048
    s_add_u32 s40, s40, 1
    v_mfma_f32_16x16x32_bf16 v[108:111], v[156:159], v[228:231], v[108:111]
    ds_read_b128 v[172:175], v251 offset:4096
    s_and_b32 s39, s40, 3
    v_mfma_f32_16x16x32_bf16 v[112:115], v[160:163], v[228:231], v[112:115]
    ds_read_b64_tr_b16 v[16:17], v249 offset:10240
    s_cmp_eq_u32 s39, 0
    s_waitcnt lgkmcnt(10)
    v_mfma_f32_16x16x32_bf16 v[116:119], v[152:155], v[232:235], v[116:119]
    ds_read_b64_tr_b16 v[18:19], v249 offset:11520
    s_cselect_b32 s39, 4294856704, s41
    v_mfma_f32_16x16x32_bf16 v[120:123], v[156:159], v[232:235], v[120:123]
    ds_read_b64_tr_b16 v[20:21], v248 offset:10304
    v_mfma_f32_16x16x32_bf16 v[124:127], v[160:163], v[232:235], v[124:127]
    ds_read_b64_tr_b16 v[22:23], v248 offset:11584
    s_waitcnt lgkmcnt(9)
    v_mfma_f32_16x16x32_bf16 v[128:131], v[152:155], v[236:239], v[128:131]
    ds_read_b64_tr_b16 v[24:25], v249 offset:10304
    v_mfma_f32_16x16x32_bf16 v[132:135], v[156:159], v[236:239], v[132:135]
    ds_read_b64_tr_b16 v[26:27], v249 offset:11584
    v_mfma_f32_16x16x32_bf16 v[136:139], v[160:163], v[236:239], v[136:139]
    ds_read_b64_tr_b16 v[28:29], v248 offset:10368
    v_mfma_f32_16x16x32_bf16 v[140:143], v[152:155], v[240:243], v[140:143]
    ds_read_b64_tr_b16 v[30:31], v248 offset:11648
    v_mfma_f32_16x16x32_bf16 v[144:147], v[156:159], v[240:243], v[144:147]
    v_add_u32 v250, s39, v250
    v_add_u32 v251, s39, v251
    v_mfma_f32_16x16x32_bf16 v[148:151], v[160:163], v[240:243], v[148:151]
    v_add_u32 v248, s39, v248
    v_add_u32 v249, s39, v249
    v_mfma_f32_16x16x16_bf16 v[32:35], v[198:199], v[180:181], v[32:35]
    v_mfma_f32_16x16x16_bf16 v[36:39], v[198:199], v[186:187], v[36:39]
    v_mfma_f32_16x16x16_bf16 v[40:43], v[198:199], v[192:193], v[40:43]
    v_mfma_f32_16x16x32_bf16 v[44:47], v[200:203], v[176:179], v[44:47]
    v_mfma_f32_16x16x32_bf16 v[48:51], v[200:203], v[182:185], v[48:51]
    v_mfma_f32_16x16x32_bf16 v[52:55], v[200:203], v[188:191], v[52:55]
    v_mfma_f32_16x16x16_bf16 v[44:47], v[204:205], v[180:181], v[44:47]
    v_mfma_f32_16x16x16_bf16 v[48:51], v[204:205], v[186:187], v[48:51]
    v_mfma_f32_16x16x16_bf16 v[52:55], v[204:205], v[192:193], v[52:55]
    v_mfma_f32_16x16x32_bf16 v[56:59], v[206:209], v[176:179], v[56:59]
    v_mfma_f32_16x16x32_bf16 v[60:63], v[206:209], v[182:185], v[60:63]
    v_mfma_f32_16x16x32_bf16 v[64:67], v[206:209], v[188:191], v[64:67]
    s_waitcnt lgkmcnt(8)
    v_mfma_f32_16x16x32_bf16 v[92:95], v[164:167], v[12:15], v[92:95]
    v_mfma_f32_16x16x32_bf16 v[96:99], v[168:171], v[12:15], v[96:99]
    s_waitcnt lgkmcnt(0)
    s_barrier
    v_mfma_f32_16x16x32_bf16 v[100:103], v[172:175], v[12:15], v[100:103]
    ds_read_b128 v[152:155], v250 offset:0
    v_mfma_f32_16x16x32_bf16 v[104:107], v[164:167], v[16:19], v[104:107]
    ds_read_b64_tr_b16 v[224:225], v248 offset:0
    v_mfma_f32_16x16x32_bf16 v[108:111], v[168:171], v[16:19], v[108:111]
    ds_read_b64_tr_b16 v[226:227], v248 offset:1280
    v_mfma_f32_16x16x32_bf16 v[112:115], v[172:175], v[16:19], v[112:115]
    ds_read_b128 v[156:159], v250 offset:2048
    v_mfma_f32_16x16x32_bf16 v[116:119], v[164:167], v[20:23], v[116:119]
    ds_read_b128 v[160:163], v250 offset:4096
    v_mfma_f32_16x16x32_bf16 v[120:123], v[168:171], v[20:23], v[120:123]
    ds_read_b64_tr_b16 v[228:229], v249 offset:0
    v_mfma_f32_16x16x32_bf16 v[124:127], v[172:175], v[20:23], v[124:127]
    ds_read_b64_tr_b16 v[230:231], v249 offset:1280
    v_mfma_f32_16x16x32_bf16 v[128:131], v[164:167], v[24:27], v[128:131]
    ds_read_b64_tr_b16 v[232:233], v248 offset:64
    v_mfma_f32_16x16x32_bf16 v[132:135], v[168:171], v[24:27], v[132:135]
    ds_read_b64_tr_b16 v[234:235], v248 offset:1344
    v_mfma_f32_16x16x32_bf16 v[136:139], v[172:175], v[24:27], v[136:139]
    ds_read_b64_tr_b16 v[236:237], v249 offset:64
    v_mfma_f32_16x16x32_bf16 v[140:143], v[164:167], v[28:31], v[140:143]
    ds_read_b64_tr_b16 v[238:239], v249 offset:1344
    v_mfma_f32_16x16x32_bf16 v[144:147], v[168:171], v[28:31], v[144:147]
    ds_read_b64_tr_b16 v[240:241], v248 offset:128
    v_mfma_f32_16x16x32_bf16 v[148:151], v[172:175], v[28:31], v[148:151]
    ds_read_b64_tr_b16 v[242:243], v248 offset:1408
    v_mfma_f32_16x16x16_bf16 v[56:59], v[210:211], v[180:181], v[56:59]
    v_mfma_f32_16x16x16_bf16 v[60:63], v[210:211], v[186:187], v[60:63]
    v_add_u32 v4, s49, v4
    v_mfma_f32_16x16x16_bf16 v[64:67], v[210:211], v[192:193], v[64:67]
    v_add_u32 v5, s49, v5
    v_mfma_f32_16x16x32_bf16 v[68:71], v[212:215], v[176:179], v[68:71]
    s_sub_u32 s49, 0, s49
    v_mfma_f32_16x16x32_bf16 v[72:75], v[212:215], v[182:185], v[72:75]
    v_mfma_f32_16x16x32_bf16 v[76:79], v[212:215], v[188:191], v[76:79]
    v_mfma_f32_16x16x16_bf16 v[68:71], v[216:217], v[180:181], v[68:71]
    v_mfma_f32_16x16x16_bf16 v[72:75], v[216:217], v[186:187], v[72:75]
    v_mfma_f32_16x16x16_bf16 v[76:79], v[216:217], v[192:193], v[76:79]
    v_mfma_f32_16x16x32_bf16 v[80:83], v[218:221], v[176:179], v[80:83]
    v_mfma_f32_16x16x32_bf16 v[84:87], v[218:221], v[182:185], v[84:87]
    v_mfma_f32_16x16x32_bf16 v[88:91], v[218:221], v[188:191], v[88:91]
    v_mfma_f32_16x16x16_bf16 v[80:83], v[222:223], v[180:181], v[80:83]
    v_mfma_f32_16x16x16_bf16 v[84:87], v[222:223], v[186:187], v[84:87]
    v_mfma_f32_16x16x16_bf16 v[88:91], v[222:223], v[192:193], v[88:91]
    s_waitcnt lgkmcnt(6)
    v_mfma_f32_16x16x32_bf16 v[92:95], v[152:155], v[224:227], v[92:95]
    ds_read_b128 v[164:167], v251 offset:0
    v_mfma_f32_16x16x32_bf16 v[96:99], v[156:159], v[224:227], v[96:99]
    ds_read_b64_tr_b16 v[12:13], v248 offset:10240
    v_mfma_f32_16x16x32_bf16 v[100:103], v[160:163], v[224:227], v[100:103]
    ds_read_b64_tr_b16 v[14:15], v248 offset:11520
    v_mfma_f32_16x16x32_bf16 v[104:107], v[152:155], v[228:231], v[104:107]
    ds_read_b128 v[168:171], v251 offset:2048
    s_add_u32 s40, s40, 1
    v_mfma_f32_16x16x32_bf16 v[108:111], v[156:159], v[228:231], v[108:111]
    ds_read_b128 v[172:175], v251 offset:4096
    s_and_b32 s39, s40, 3
    v_mfma_f32_16x16x32_bf16 v[112:115], v[160:163], v[228:231], v[112:115]
    ds_read_b64_tr_b16 v[16:17], v249 offset:10240
    s_cmp_eq_u32 s39, 0
    s_waitcnt lgkmcnt(10)
    v_mfma_f32_16x16x32_bf16 v[116:119], v[152:155], v[232:235], v[116:119]
    ds_read_b64_tr_b16 v[18:19], v249 offset:11520
    s_cselect_b32 s39, 4294856704, s41
    v_mfma_f32_16x16x32_bf16 v[120:123], v[156:159], v[232:235], v[120:123]
    ds_read_b64_tr_b16 v[20:21], v248 offset:10304
    v_mfma_f32_16x16x32_bf16 v[124:127], v[160:163], v[232:235], v[124:127]
    ds_read_b64_tr_b16 v[22:23], v248 offset:11584
    s_waitcnt lgkmcnt(9)
    v_mfma_f32_16x16x32_bf16 v[128:131], v[152:155], v[236:239], v[128:131]
    ds_read_b64_tr_b16 v[24:25], v249 offset:10304
    v_mfma_f32_16x16x32_bf16 v[132:135], v[156:159], v[236:239], v[132:135]
    ds_read_b64_tr_b16 v[26:27], v249 offset:11584
    v_mfma_f32_16x16x32_bf16 v[136:139], v[160:163], v[236:239], v[136:139]
    ds_read_b64_tr_b16 v[28:29], v248 offset:10368
    v_mfma_f32_16x16x32_bf16 v[140:143], v[152:155], v[240:243], v[140:143]
    ds_read_b64_tr_b16 v[30:31], v248 offset:11648
    v_mfma_f32_16x16x32_bf16 v[144:147], v[156:159], v[240:243], v[144:147]
    v_add_u32 v250, s39, v250
    v_add_u32 v251, s39, v251
    v_mfma_f32_16x16x32_bf16 v[148:151], v[160:163], v[240:243], v[148:151]
    v_add_u32 v248, s39, v248
    v_add_u32 v249, s39, v249
    s_waitcnt lgkmcnt(8)
    v_mfma_f32_16x16x32_bf16 v[92:95], v[164:167], v[12:15], v[92:95]
    v_mfma_f32_16x16x32_bf16 v[96:99], v[168:171], v[12:15], v[96:99]
    s_waitcnt lgkmcnt(0)
    s_barrier
    v_mfma_f32_16x16x32_bf16 v[100:103], v[172:175], v[12:15], v[100:103]
    ds_read_b128 v[152:155], v250 offset:0
    v_mfma_f32_16x16x32_bf16 v[104:107], v[164:167], v[16:19], v[104:107]
    ds_read_b64_tr_b16 v[224:225], v248 offset:0
    s_add_u32 s47, s47, 1
    v_mfma_f32_16x16x32_bf16 v[108:111], v[168:171], v[16:19], v[108:111]
    ds_read_b64_tr_b16 v[226:227], v248 offset:1280
    s_cmp_lt_u32 s47, 3
    v_mfma_f32_16x16x32_bf16 v[112:115], v[172:175], v[16:19], v[112:115]
    ds_read_b128 v[156:159], v250 offset:2048
    v_mfma_f32_16x16x32_bf16 v[116:119], v[164:167], v[20:23], v[116:119]
    ds_read_b128 v[160:163], v250 offset:4096
    v_cvt_pk_bf16_f32 v194, v92, v93
    v_cvt_pk_bf16_f32 v195, v94, v95
    v_mfma_f32_16x16x32_bf16 v[120:123], v[168:171], v[20:23], v[120:123]
    ds_read_b64_tr_b16 v[228:229], v249 offset:0
    v_cvt_pk_bf16_f32 v196, v96, v97
    v_cvt_pk_bf16_f32 v197, v98, v99
    v_mfma_f32_16x16x32_bf16 v[124:127], v[172:175], v[20:23], v[124:127]
    ds_read_b64_tr_b16 v[230:231], v249 offset:1280
    v_cvt_pk_bf16_f32 v198, v100, v101
    v_cvt_pk_bf16_f32 v199, v102, v103
    v_mfma_f32_16x16x32_bf16 v[128:131], v[164:167], v[24:27], v[128:131]
    ds_read_b64_tr_b16 v[232:233], v248 offset:64
    v_cvt_pk_bf16_f32 v200, v104, v105
    v_cvt_pk_bf16_f32 v201, v106, v107
    v_mfma_f32_16x16x32_bf16 v[132:135], v[168:171], v[24:27], v[132:135]
    ds_read_b64_tr_b16 v[234:235], v248 offset:1344
    v_cvt_pk_bf16_f32 v202, v108, v109
    v_cvt_pk_bf16_f32 v203, v110, v111
    v_mfma_f32_16x16x32_bf16 v[136:139], v[172:175], v[24:27], v[136:139]
    ds_read_b64_tr_b16 v[236:237], v249 offset:64
    v_cvt_pk_bf16_f32 v204, v112, v113
    v_cvt_pk_bf16_f32 v205, v114, v115
    v_mfma_f32_16x16x32_bf16 v[140:143], v[164:167], v[28:31], v[140:143]
    ds_read_b64_tr_b16 v[238:239], v249 offset:1344
    v_cvt_pk_bf16_f32 v206, v116, v117
    v_cvt_pk_bf16_f32 v207, v118, v119
    v_mfma_f32_16x16x32_bf16 v[144:147], v[168:171], v[28:31], v[144:147]
    ds_read_b64_tr_b16 v[240:241], v248 offset:128
    v_cvt_pk_bf16_f32 v208, v120, v121
    v_cvt_pk_bf16_f32 v209, v122, v123
    v_mfma_f32_16x16x32_bf16 v[148:151], v[172:175], v[28:31], v[148:151]
    ds_read_b64_tr_b16 v[242:243], v248 offset:1408
    v_cvt_pk_bf16_f32 v210, v124, v125
    v_cvt_pk_bf16_f32 v211, v126, v127
    s_cbranch_scc1 KA_HLOOP
    s_waitcnt lgkmcnt(6)
    v_mfma_f32_16x16x32_bf16 v[92:95], v[152:155], v[224:227], 0
    ds_read_b128 v[164:167], v251 offset:0
    v_mfma_f32_16x16x32_bf16 v[96:99], v[156:159], v[224:227], 0
    ds_read_b64_tr_b16 v[12:13], v248 offset:10240
    v_cvt_pk_bf16_f32 v212, v128, v129
    v_cvt_pk_bf16_f32 v213, v130, v131
    v_mfma_f32_16x16x32_bf16 v[100:103], v[160:163], v[224:227], 0
    ds_read_b64_tr_b16 v[14:15], v248 offset:11520
    v_cvt_pk_bf16_f32 v214, v132, v133
    v_cvt_pk_bf16_f32 v215, v134, v135
    v_mfma_f32_16x16x32_bf16 v[104:107], v[152:155], v[228:231], 0
    ds_read_b128 v[168:171], v251 offset:2048
    s_add_u32 s40, s40, 1
    v_cvt_pk_bf16_f32 v216, v136, v137
    v_cvt_pk_bf16_f32 v217, v138, v139
    v_mfma_f32_16x16x32_bf16 v[108:111], v[156:159], v[228:231], 0
    ds_read_b128 v[172:175], v251 offset:4096
    s_and_b32 s39, s40, 3
    v_cvt_pk_bf16_f32 v218, v140, v141
    v_cvt_pk_bf16_f32 v219, v142, v143
    v_mfma_f32_16x16x32_bf16 v[112:115], v[160:163], v[228:231], 0
    ds_read_b64_tr_b16 v[16:17], v249 offset:10240
    s_cmp_eq_u32 s39, 0
    v_cvt_pk_bf16_f32 v220, v144, v145
    v_cvt_pk_bf16_f32 v221, v146, v147
    s_waitcnt lgkmcnt(10)
    v_mfma_f32_16x16x32_bf16 v[116:119], v[152:155], v[232:235], 0
    ds_read_b64_tr_b16 v[18:19], v249 offset:11520
    s_cselect_b32 s39, 4294856704, s41
    v_cvt_pk_bf16_f32 v222, v148, v149
    v_cvt_pk_bf16_f32 v223, v150, v151
    v_mfma_f32_16x16x32_bf16 v[120:123], v[156:159], v[232:235], 0
    ds_read_b64_tr_b16 v[20:21], v248 offset:10304
    v_mfma_f32_16x16x32_bf16 v[124:127], v[160:163], v[232:235], 0
    ds_read_b64_tr_b16 v[22:23], v248 offset:11584
    s_waitcnt lgkmcnt(9)
    v_mfma_f32_16x16x32_bf16 v[128:131], v[152:155], v[236:239], 0
    ds_read_b64_tr_b16 v[24:25], v249 offset:10304
    v_mfma_f32_16x16x32_bf16 v[132:135], v[156:159], v[236:239], 0
    ds_read_b64_tr_b16 v[26:27], v249 offset:11584
    v_mfma_f32_16x16x32_bf16 v[136:139], v[160:163], v[236:239], 0
    ds_read_b64_tr_b16 v[28:29], v248 offset:10368
    v_mfma_f32_16x16x32_bf16 v[140:143], v[152:155], v[240:243], 0
    ds_read_b64_tr_b16 v[30:31], v248 offset:11648
    v_mfma_f32_16x16x32_bf16 v[144:147], v[156:159], v[240:243], 0
    v_add_u32 v250, s39, v250
    v_add_u32 v251, s39, v251
    v_mfma_f32_16x16x32_bf16 v[148:151], v[160:163], v[240:243], 0
    v_add_u32 v248, s39, v248
    v_add_u32 v249, s39, v249
    s_waitcnt lgkmcnt(8)
    v_mfma_f32_16x16x32_bf16 v[92:95], v[164:167], v[12:15], v[92:95]
    v_mfma_f32_16x16x32_bf16 v[96:99], v[168:171], v[12:15], v[96:99]
    s_waitcnt lgkmcnt(0)
    s_barrier
    v_mfma_f32_16x16x32_bf16 v[100:103], v[172:175], v[12:15], v[100:103]
    ds_read_b128 v[176:179], v4 offset:0
    v_mfma_f32_16x16x32_bf16 v[104:107], v[164:167], v[16:19], v[104:107]
    ds_read_b64 v[180:181], v5 offset:0
    v_mfma_f32_16x16x32_bf16 v[108:111], v[168:171], v[16:19], v[108:111]
    ds_read_b128 v[182:185], v4 offset:1024
    v_mfma_f32_16x16x32_bf16 v[112:115], v[172:175], v[16:19], v[112:115]
    ds_read_b64 v[186:187], v5 offset:512
    v_mfma_f32_16x16x32_bf16 v[116:119], v[164:167], v[20:23], v[116:119]
    ds_read_b128 v[188:191], v4 offset:2048
    v_mfma_f32_16x16x32_bf16 v[120:123], v[168:171], v[20:23], v[120:123]
    ds_read_b64 v[192:193], v5 offset:1024
    v_mfma_f32_16x16x32_bf16 v[124:127], v[172:175], v[20:23], v[124:127]
    ds_read_b128 v[152:155], v250 offset:0
    v_mfma_f32_16x16x32_bf16 v[128:131], v[164:167], v[24:27], v[128:131]
    ds_read_b64_tr_b16 v[224:225], v248 offset:0
    v_mfma_f32_16x16x32_bf16 v[132:135], v[168:171], v[24:27], v[132:135]
    ds_read_b64_tr_b16 v[226:227], v248 offset:1280
    v_mfma_f32_16x16x32_bf16 v[136:139], v[172:175], v[24:27], v[136:139]
    ds_read_b128 v[156:159], v250 offset:2048
    v_mfma_f32_16x16x32_bf16 v[140:143], v[164:167], v[28:31], v[140:143]
    ds_read_b128 v[160:163], v250 offset:4096
    v_mfma_f32_16x16x32_bf16 v[144:147], v[168:171], v[28:31], v[144:147]
    ds_read_b64_tr_b16 v[228:229], v249 offset:0
    v_mfma_f32_16x16x32_bf16 v[148:151], v[172:175], v[28:31], v[148:151]
    ds_read_b64_tr_b16 v[230:231], v249 offset:1280
    s_waitcnt lgkmcnt(7)
    v_mfma_f32_16x16x32_bf16 v[32:35], v[194:197], v[176:179], v[32:35]
    ds_read_b64_tr_b16 v[232:233], v248 offset:64
    v_mfma_f32_16x16x32_bf16 v[36:39], v[194:197], v[182:185], v[36:39]
    ds_read_b64_tr_b16 v[234:235], v248 offset:1344
    v_mfma_f32_16x16x32_bf16 v[40:43], v[194:197], v[188:191], v[40:43]
    ds_read_b64_tr_b16 v[236:237], v249 offset:64
    ds_read_b64_tr_b16 v[238:239], v249 offset:1344
    ds_read_b64_tr_b16 v[240:241], v248 offset:128
    ds_read_b64_tr_b16 v[242:243], v248 offset:1408
    s_waitcnt lgkmcnt(6)
    v_mfma_f32_16x16x32_bf16 v[92:95], v[152:155], v[224:227], v[92:95]
    ds_read_b128 v[164:167], v251 offset:0
    v_mfma_f32_16x16x32_bf16 v[96:99], v[156:159], v[224:227], v[96:99]
    ds_read_b64_tr_b16 v[12:13], v248 offset:10240
    v_mfma_f32_16x16x32_bf16 v[100:103], v[160:163], v[224:227], v[100:103]
    ds_read_b64_tr_b16 v[14:15], v248 offset:11520
    v_mfma_f32_16x16x32_bf16 v[104:107], v[152:155], v[228:231], v[104:107]
    ds_read_b128 v[168:171], v251 offset:2048
    s_add_u32 s40, s40, 1
    v_mfma_f32_16x16x32_bf16 v[108:111], v[156:159], v[228:231], v[108:111]
    ds_read_b128 v[172:175], v251 offset:4096
    s_and_b32 s39, s40, 3
    v_mfma_f32_16x16x32_bf16 v[112:115], v[160:163], v[228:231], v[112:115]
    ds_read_b64_tr_b16 v[16:17], v249 offset:10240
    s_cmp_eq_u32 s39, 0
    s_waitcnt lgkmcnt(10)
    v_mfma_f32_16x16x32_bf16 v[116:119], v[152:155], v[232:235], v[116:119]
    ds_read_b64_tr_b16 v[18:19], v249 offset:11520
    s_cselect_b32 s39, 4294856704, s41
    v_mfma_f32_16x16x32_bf16 v[120:123], v[156:159], v[232:235], v[120:123]
    ds_read_b64_tr_b16 v[20:21], v248 offset:10304
    v_mfma_f32_16x16x32_bf16 v[124:127], v[160:163], v[232:235], v[124:127]
    ds_read_b64_tr_b16 v[22:23], v248 offset:11584
    s_waitcnt lgkmcnt(9)
    v_mfma_f32_16x16x32_bf16 v[128:131], v[152:155], v[236:239], v[128:131]
    ds_read_b64_tr_b16 v[24:25], v249 offset:10304
    v_mfma_f32_16x16x32_bf16 v[132:135], v[156:159], v[236:239], v[132:135]
    ds_read_b64_tr_b16 v[26:27], v249 offset:11584
    v_mfma_f32_16x16x32_bf16 v[136:139], v[160:163], v[236:239], v[136:139]
    ds_read_b64_tr_b16 v[28:29], v248 offset:10368
    v_mfma_f32_16x16x32_bf16 v[140:143], v[152:155], v[240:243], v[140:143]
    ds_read_b64_tr_b16 v[30:31], v248 offset:11648
    v_mfma_f32_16x16x32_bf16 v[144:147], v[156:159], v[240:243], v[144:147]
    v_add_u32 v250, s39, v250
    v_add_u32 v251, s39, v251
    v_mfma_f32_16x16x32_bf16 v[148:151], v[160:163], v[240:243], v[148:151]
    v_add_u32 v248, s39, v248
    v_add_u32 v249, s39, v249
    v_mfma_f32_16x16x16_bf16 v[32:35], v[198:199], v[180:181], v[32:35]
    v_mfma_f32_16x16x16_bf16 v[36:39], v[198:199], v[186:187], v[36:39]
    v_mfma_f32_16x16x16_bf16 v[40:43], v[198:199], v[192:193], v[40:43]
    v_mfma_f32_16x16x32_bf16 v[44:47], v[200:203], v[176:179], v[44:47]
    v_mfma_f32_16x16x32_bf16 v[48:51], v[200:203], v[182:185], v[48:51]
    v_mfma_f32_16x16x32_bf16 v[52:55], v[200:203], v[188:191], v[52:55]
    v_mfma_f32_16x16x16_bf16 v[44:47], v[204:205], v[180:181], v[44:47]
    v_mfma_f32_16x16x16_bf16 v[48:51], v[204:205], v[186:187], v[48:51]
    v_mfma_f32_16x16x16_bf16 v[52:55], v[204:205], v[192:193], v[52:55]
    v_mfma_f32_16x16x32_bf16 v[56:59], v[206:209], v[176:179], v[56:59]
    v_mfma_f32_16x16x32_bf16 v[60:63], v[206:209], v[182:185], v[60:63]
    v_mfma_f32_16x16x32_bf16 v[64:67], v[206:209], v[188:191], v[64:67]
    s_waitcnt lgkmcnt(8)
    v_mfma_f32_16x16x32_bf16 v[92:95], v[164:167], v[12:15], v[92:95]
    v_mfma_f32_16x16x32_bf16 v[96:99], v[168:171], v[12:15], v[96:99]
    s_waitcnt lgkmcnt(0)
    s_barrier
    v_mfma_f32_16x16x32_bf16 v[100:103], v[172:175], v[12:15], v[100:103]
    ds_read_b128 v[152:155], v250 offset:0
    v_mfma_f32_16x16x32_bf16 v[104:107], v[164:167], v[16:19], v[104:107]
    ds_read_b64_tr_b16 v[224:225], v248 offset:0
    v_mfma_f32_16x16x32_bf16 v[108:111], v[168:171], v[16:19], v[108:111]
    ds_read_b64_tr_b16 v[226:227], v248 offset:1280
    v_mfma_f32_16x16x32_bf16 v[112:115], v[172:175], v[16:19], v[112:115]
    ds_read_b128 v[156:159], v250 offset:2048
    v_mfma_f32_16x16x32_bf16 v[116:119], v[164:167], v[20:23], v[116:119]
    ds_read_b128 v[160:163], v250 offset:4096
    v_mfma_f32_16x16x32_bf16 v[120:123], v[168:171], v[20:23], v[120:123]
    ds_read_b64_tr_b16 v[228:229], v249 offset:0
    v_mfma_f32_16x16x32_bf16 v[124:127], v[172:175], v[20:23], v[124:127]
    ds_read_b64_tr_b16 v[230:231], v249 offset:1280
    v_mfma_f32_16x16x32_bf16 v[128:131], v[164:167], v[24:27], v[128:131]
    ds_read_b64_tr_b16 v[232:233], v248 offset:64
    v_mfma_f32_16x16x32_bf16 v[132:135], v[168:171], v[24:27], v[132:135]
    ds_read_b64_tr_b16 v[234:235], v248 offset:1344
    v_mfma_f32_16x16x32_bf16 v[136:139], v[172:175], v[24:27], v[136:139]
    ds_read_b64_tr_b16 v[236:237], v249 offset:64
    v_mfma_f32_16x16x32_bf16 v[140:143], v[164:167], v[28:31], v[140:143]
    ds_read_b64_tr_b16 v[238:239], v249 offset:1344
    v_mfma_f32_16x16x32_bf16 v[144:147], v[168:171], v[28:31], v[144:147]
    ds_read_b64_tr_b16 v[240:241], v248 offset:128
    v_mfma_f32_16x16x32_bf16 v[148:151], v[172:175], v[28:31], v[148:151]
    ds_read_b64_tr_b16 v[242:243], v248 offset:1408
    v_mfma_f32_16x16x16_bf16 v[56:59], v[210:211], v[180:181], v[56:59]
    v_mfma_f32_16x16x16_bf16 v[60:63], v[210:211], v[186:187], v[60:63]
    v_add_u32 v4, s49, v4
    v_mfma_f32_16x16x16_bf16 v[64:67], v[210:211], v[192:193], v[64:67]
    v_add_u32 v5, s49, v5
    v_mfma_f32_16x16x32_bf16 v[68:71], v[212:215], v[176:179], v[68:71]
    s_sub_u32 s49, 0, s49
    v_mfma_f32_16x16x32_bf16 v[72:75], v[212:215], v[182:185], v[72:75]
    v_mfma_f32_16x16x32_bf16 v[76:79], v[212:215], v[188:191], v[76:79]
    v_mfma_f32_16x16x16_bf16 v[68:71], v[216:217], v[180:181], v[68:71]
    v_mfma_f32_16x16x16_bf16 v[72:75], v[216:217], v[186:187], v[72:75]
    v_mfma_f32_16x16x16_bf16 v[76:79], v[216:217], v[192:193], v[76:79]
    v_mfma_f32_16x16x32_bf16 v[80:83], v[218:221], v[176:179], v[80:83]
    v_mfma_f32_16x16x32_bf16 v[84:87], v[218:221], v[182:185], v[84:87]
    v_mfma_f32_16x16x32_bf16 v[88:91], v[218:221], v[188:191], v[88:91]
    v_mfma_f32_16x16x16_bf16 v[80:83], v[222:223], v[180:181], v[80:83]
    v_mfma_f32_16x16x16_bf16 v[84:87], v[222:223], v[186:187], v[84:87]
    v_mfma_f32_16x16x16_bf16 v[88:91], v[222:223], v[192:193], v[88:91]
    s_waitcnt lgkmcnt(6)
    v_mfma_f32_16x16x32_bf16 v[92:95], v[152:155], v[224:227], v[92:95]
    ds_read_b128 v[164:167], v251 offset:0
    v_mfma_f32_16x16x32_bf16 v[96:99], v[156:159], v[224:227], v[96:99]
    ds_read_b64_tr_b16 v[12:13], v248 offset:10240
    v_mfma_f32_16x16x32_bf16 v[100:103], v[160:163], v[224:227], v[100:103]
    ds_read_b64_tr_b16 v[14:15], v248 offset:11520
    v_mfma_f32_16x16x32_bf16 v[104:107], v[152:155], v[228:231], v[104:107]
    ds_read_b128 v[168:171], v251 offset:2048
    v_mfma_f32_16x16x32_bf16 v[108:111], v[156:159], v[228:231], v[108:111]
    ds_read_b128 v[172:175], v251 offset:4096
    v_mfma_f32_16x16x32_bf16 v[112:115], v[160:163], v[228:231], v[112:115]
    ds_read_b64_tr_b16 v[16:17], v249 offset:10240
    s_waitcnt lgkmcnt(10)
    v_mfma_f32_16x16x32_bf16 v[116:119], v[152:155], v[232:235], v[116:119]
    ds_read_b64_tr_b16 v[18:19], v249 offset:11520
    v_mfma_f32_16x16x32_bf16 v[120:123], v[156:159], v[232:235], v[120:123]
    ds_read_b64_tr_b16 v[20:21], v248 offset:10304
    v_mfma_f32_16x16x32_bf16 v[124:127], v[160:163], v[232:235], v[124:127]
    ds_read_b64_tr_b16 v[22:23], v248 offset:11584
    s_waitcnt lgkmcnt(9)
    v_mfma_f32_16x16x32_bf16 v[128:131], v[152:155], v[236:239], v[128:131]
    ds_read_b64_tr_b16 v[24:25], v249 offset:10304
    v_mfma_f32_16x16x32_bf16 v[132:135], v[156:159], v[236:239], v[132:135]
    ds_read_b64_tr_b16 v[26:27], v249 offset:11584
    v_mfma_f32_16x16x32_bf16 v[136:139], v[160:163], v[236:239], v[136:139]
    ds_read_b64_tr_b16 v[28:29], v248 offset:10368
    v_mfma_f32_16x16x32_bf16 v[140:143], v[152:155], v[240:243], v[140:143]
    ds_read_b64_tr_b16 v[30:31], v248 offset:11648
    v_mfma_f32_16x16x32_bf16 v[144:147], v[156:159], v[240:243], v[144:147]
    v_mfma_f32_16x16x32_bf16 v[148:151], v[160:163], v[240:243], v[148:151]
    s_waitcnt lgkmcnt(6)
    v_mfma_f32_16x16x32_bf16 v[92:95], v[164:167], v[12:15], v[92:95]
    ds_read_b128 v[176:179], v4 offset:0
    v_mfma_f32_16x16x32_bf16 v[96:99], v[168:171], v[12:15], v[96:99]
    ds_read_b64 v[180:181], v5 offset:0
    v_mfma_f32_16x16x32_bf16 v[100:103], v[172:175], v[12:15], v[100:103]
    ds_read_b128 v[182:185], v4 offset:1024
    v_mfma_f32_16x16x32_bf16 v[104:107], v[164:167], v[16:19], v[104:107]
    ds_read_b64 v[186:187], v5 offset:512
    v_mfma_f32_16x16x32_bf16 v[108:111], v[168:171], v[16:19], v[108:111]
    ds_read_b128 v[188:191], v4 offset:2048
    v_mfma_f32_16x16x32_bf16 v[112:115], v[172:175], v[16:19], v[112:115]
    ds_read_b64 v[192:193], v5 offset:1024
    s_waitcnt lgkmcnt(6)
    v_mfma_f32_16x16x32_bf16 v[116:119], v[164:167], v[20:23], v[116:119]
    v_cvt_pk_bf16_f32 v194, v92, v93
    v_cvt_pk_bf16_f32 v195, v94, v95
    v_mfma_f32_16x16x32_bf16 v[120:123], v[168:171], v[20:23], v[120:123]
    v_cvt_pk_bf16_f32 v196, v96, v97
    v_cvt_pk_bf16_f32 v197, v98, v99
    v_mfma_f32_16x16x32_bf16 v[124:127], v[172:175], v[20:23], v[124:127]
    v_cvt_pk_bf16_f32 v198, v100, v101
    v_cvt_pk_bf16_f32 v199, v102, v103
    v_mfma_f32_16x16x32_bf16 v[128:131], v[164:167], v[24:27], v[128:131]
    v_cvt_pk_bf16_f32 v200, v104, v105
    v_cvt_pk_bf16_f32 v201, v106, v107
    v_mfma_f32_16x16x32_bf16 v[132:135], v[168:171], v[24:27], v[132:135]
    v_cvt_pk_bf16_f32 v202, v108, v109
    v_cvt_pk_bf16_f32 v203, v110, v111
    v_mfma_f32_16x16x32_bf16 v[136:139], v[172:175], v[24:27], v[136:139]
    v_cvt_pk_bf16_f32 v204, v112, v113
    v_cvt_pk_bf16_f32 v205, v114, v115
    v_mfma_f32_16x16x32_bf16 v[140:143], v[164:167], v[28:31], v[140:143]
    v_cvt_pk_bf16_f32 v206, v116, v117
    v_cvt_pk_bf16_f32 v207, v118, v119
    v_mfma_f32_16x16x32_bf16 v[144:147], v[168:171], v[28:31], v[144:147]
    v_cvt_pk_bf16_f32 v208, v120, v121
    v_cvt_pk_bf16_f32 v209, v122, v123
    v_mfma_f32_16x16x32_bf16 v[148:151], v[172:175], v[28:31], v[148:151]
    v_cvt_pk_bf16_f32 v210, v124, v125
    v_cvt_pk_bf16_f32 v211, v126, v127
    s_waitcnt lgkmcnt(0)
    v_mfma_f32_16x16x32_bf16 v[32:35], v[194:197], v[176:179], v[32:35]
    v_mfma_f32_16x16x32_bf16 v[44:47], v[200:203], v[176:179], v[44:47]
    v_cvt_pk_bf16_f32 v212, v128, v129
    v_cvt_pk_bf16_f32 v213, v130, v131
    v_mfma_f32_16x16x32_bf16 v[56:59], v[206:209], v[176:179], v[56:59]
    v_cvt_pk_bf16_f32 v214, v132, v133
    v_cvt_pk_bf16_f32 v215, v134, v135
    v_mfma_f32_16x16x16_bf16 v[32:35], v[198:199], v[180:181], v[32:35]
    v_cvt_pk_bf16_f32 v216, v136, v137
    v_cvt_pk_bf16_f32 v217, v138, v139
    v_mfma_f32_16x16x16_bf16 v[44:47], v[204:205], v[180:181], v[44:47]
    v_cvt_pk_bf16_f32 v218, v140, v141
    v_cvt_pk_bf16_f32 v219, v142, v143
    v_mfma_f32_16x16x16_bf16 v[56:59], v[210:211], v[180:181], v[56:59]
    v_cvt_pk_bf16_f32 v220, v144, v145
    v_cvt_pk_bf16_f32 v221, v146, v147
    v_mfma_f32_16x16x32_bf16 v[36:39], v[194:197], v[182:185], v[36:39]
    v_cvt_pk_bf16_f32 v222, v148, v149
    v_cvt_pk_bf16_f32 v223, v150, v151
    v_mfma_f32_16x16x32_bf16 v[48:51], v[200:203], v[182:185], v[48:51]
    v_mfma_f32_16x16x32_bf16 v[60:63], v[206:209], v[182:185], v[60:63]
    v_mfma_f32_16x16x32_bf16 v[68:71], v[212:215], v[176:179], v[68:71]
    v_mfma_f32_16x16x32_bf16 v[80:83], v[218:221], v[176:179], v[80:83]
    v_mfma_f32_16x16x16_bf16 v[68:71], v[216:217], v[180:181], v[68:71]
    v_mfma_f32_16x16x16_bf16 v[80:83], v[222:223], v[180:181], v[80:83]
    v_mfma_f32_16x16x16_bf16 v[36:39], v[198:199], v[186:187], v[36:39]
    v_cvt_pk_bf16_f32 v92, v32, v33
    v_cvt_pk_bf16_f32 v93, v34, v35
    v_mfma_f32_16x16x16_bf16 v[48:51], v[204:205], v[186:187], v[48:51]
    v_cvt_pk_bf16_f32 v94, v44, v45
    v_cvt_pk_bf16_f32 v95, v46, v47
    v_mfma_f32_16x16x16_bf16 v[60:63], v[210:211], v[186:187], v[60:63]
    v_cvt_pk_bf16_f32 v96, v56, v57
    v_cvt_pk_bf16_f32 v97, v58, v59
    v_mfma_f32_16x16x32_bf16 v[72:75], v[212:215], v[182:185], v[72:75]
    v_cvt_pk_bf16_f32 v98, v68, v69
    v_cvt_pk_bf16_f32 v99, v70, v71
    v_mfma_f32_16x16x32_bf16 v[84:87], v[218:221], v[182:185], v[84:87]
    v_cvt_pk_bf16_f32 v100, v80, v81
    v_cvt_pk_bf16_f32 v101, v82, v83
    v_mfma_f32_16x16x16_bf16 v[72:75], v[216:217], v[186:187], v[72:75]
    v_permlane16_swap_b32 v92, v94
    v_permlane16_swap_b32 v93, v95
    v_mfma_f32_16x16x16_bf16 v[84:87], v[222:223], v[186:187], v[84:87]
    v_permlane16_swap_b32 v96, v98
    v_permlane16_swap_b32 v97, v99
    v_mfma_f32_16x16x32_bf16 v[40:43], v[194:197], v[188:191], v[40:43]
    buffer_store_dwordx2 v[100:101], v255, s[32:35], s44 offen offset:2048 sc1
    buffer_store_dwordx4 v[92:95], v254, s[32:35], s44 offen offset:0 sc1
    v_mfma_f32_16x16x32_bf16 v[52:55], v[200:203], v[188:191], v[52:55]
    buffer_store_dwordx4 v[96:99], v254, s[32:35], s44 offen offset:1024 sc1
    s_add_u32 s44, s44, 163840
    v_mfma_f32_16x16x32_bf16 v[64:67], v[206:209], v[188:191], v[64:67]
    v_cvt_pk_bf16_f32 v104, v36, v37
    v_cvt_pk_bf16_f32 v105, v38, v39
    v_mfma_f32_16x16x32_bf16 v[76:79], v[212:215], v[188:191], v[76:79]
    v_cvt_pk_bf16_f32 v106, v48, v49
    v_cvt_pk_bf16_f32 v107, v50, v51
    v_mfma_f32_16x16x32_bf16 v[88:91], v[218:221], v[188:191], v[88:91]
    v_cvt_pk_bf16_f32 v108, v60, v61
    v_cvt_pk_bf16_f32 v109, v62, v63
    v_mfma_f32_16x16x16_bf16 v[40:43], v[198:199], v[192:193], v[40:43]
    v_cvt_pk_bf16_f32 v110, v72, v73
    v_cvt_pk_bf16_f32 v111, v74, v75
    v_mfma_f32_16x16x16_bf16 v[52:55], v[204:205], v[192:193], v[52:55]
    v_cvt_pk_bf16_f32 v112, v84, v85
    v_cvt_pk_bf16_f32 v113, v86, v87
    v_mfma_f32_16x16x16_bf16 v[64:67], v[210:211], v[192:193], v[64:67]
    v_permlane16_swap_b32 v104, v106
    v_permlane16_swap_b32 v105, v107
    v_mfma_f32_16x16x16_bf16 v[76:79], v[216:217], v[192:193], v[76:79]
    v_permlane16_swap_b32 v108, v110
    v_permlane16_swap_b32 v109, v111
    v_mfma_f32_16x16x16_bf16 v[88:91], v[222:223], v[192:193], v[88:91]
    buffer_store_dwordx2 v[112:113], v255, s[32:35], s44 offen offset:2048 sc1
    buffer_store_dwordx4 v[104:107], v254, s[32:35], s44 offen offset:0 sc1
    buffer_store_dwordx4 v[108:111], v254, s[32:35], s44 offen offset:1024 sc1
    s_add_u32 s44, s44, 163840
    v_cvt_pk_bf16_f32 v116, v40, v41
    v_cvt_pk_bf16_f32 v117, v42, v43
    v_cvt_pk_bf16_f32 v118, v52, v53
    v_cvt_pk_bf16_f32 v119, v54, v55
    v_cvt_pk_bf16_f32 v120, v64, v65
    v_cvt_pk_bf16_f32 v121, v66, v67
    v_cvt_pk_bf16_f32 v122, v76, v77
    v_cvt_pk_bf16_f32 v123, v78, v79
    v_cvt_pk_bf16_f32 v124, v88, v89
    v_cvt_pk_bf16_f32 v125, v90, v91
    v_permlane16_swap_b32 v116, v118
    v_permlane16_swap_b32 v117, v119
    v_permlane16_swap_b32 v120, v122
    v_permlane16_swap_b32 v121, v123
    buffer_store_dwordx2 v[124:125], v255, s[32:35], s44 offen offset:2048 sc1
    buffer_store_dwordx4 v[116:119], v254, s[32:35], s44 offen offset:0 sc1
    buffer_store_dwordx4 v[120:123], v254, s[32:35], s44 offen offset:1024 sc1
    s_lshl_b32 s36, s3, 1
    s_add_u32 s36, s36, s25
    v_lshlrev_b32 v3, s36, v3
    s_waitcnt vmcnt(0)
    buffer_atomic_or v3, v2, s[4:7], 0 offen
    s_endpgm
KA_END:
    s_endpgm
.section .rodata,"a"
.p2align 6
.amdhsa_kernel standalone__mha_block_cached__near_ridge_kernel
  .amdhsa_next_free_vgpr 256
  .amdhsa_next_free_sgpr 72
  .amdhsa_accum_offset 256
  .amdhsa_group_segment_fixed_size 0
  .amdhsa_kernarg_size 64
  .amdhsa_user_sgpr_count 2
  .amdhsa_user_sgpr_kernarg_segment_ptr 1
  .amdhsa_system_sgpr_workgroup_id_x 1
.end_amdhsa_kernel
```
